```python
import torch

def _softmax(x, axis=-1):
    return torch.softmax(x, dim=axis)
def _gelu(x):
    return torch.nn.functional.gelu(x, approximate="tanh")
def _silu(x):
    return torch.nn.functional.silu(x)
def _sigmoid(x):
    return torch.sigmoid(x)
def _layernorm(x, axis=-1, eps=1e-5):
    m = x.mean(dim=axis, keepdim=True)
    v = x.var(dim=axis, keepdim=True, unbiased=False)
    return (x - m) / torch.sqrt(v + eps)
def _scatter_add(tgt, idx, src, axis=0):
    return tgt.clone().index_add_(axis, idx, src)
def _segment_sum(src, seg, n):
    out = torch.zeros((n,) + src.shape[1:], dtype=src.dtype)
    return out.index_add_(0, seg, src)
def _pad(x, pw):
    flat = tuple(v for pair in reversed(pw) for v in pair)
    return torch.nn.functional.pad(x, flat)

kernel_name = 'standalone__linear_kernel_hedgehog__prompt'

def setup_inputs():

    _w = (lambda a: (lambda t: t.to(torch.bfloat16) if t.is_floating_point() else t)(torch.as_tensor(a)))
    B, S, D, H = 1, 2048, 640, 32
    Dh = D // H
    return {
        "x": _w((lambda *s: torch.randn(*s, dtype=torch.bfloat16) * 0.4)(B, S, D)),
        "wqkv": _w((lambda *s: torch.randn(*s, dtype=torch.bfloat16) * 0.4)(D, 3 * D)),
        "w_phi": _w((lambda *s: torch.randn(*s, dtype=torch.bfloat16) * 0.4)(H, Dh, Dh) * (Dh ** -0.5)),
        "wo": _w((lambda *s: torch.randn(*s, dtype=torch.bfloat16) * 0.05)(D, D)),
    }

def reference(x, wqkv, w_phi, wo):
    B, S, D = x.shape
    H = 32; Dh = D // H
    qkv = (lambda x, *d: x.permute(*d))((x @ wqkv).reshape(B, S, 3, H, Dh), 2, 0, 3, 1, 4)
    q, k, v = qkv[0], qkv[1], qkv[2]
    pq = torch.einsum("bhsd,hdf->bhsf", q, w_phi)
    pk = torch.einsum("bhsd,hdf->bhsf", k, w_phi)
    phi_q = torch.concatenate([_softmax(pq, axis=-1), _softmax(-pq, axis=-1)], axis=-1)
    phi_k = torch.concatenate([_softmax(pk, axis=-1), _softmax(-pk, axis=-1)], axis=-1)
    kv = torch.einsum("bhsf,bhsd->bhfd", phi_k, v)
    z  = torch.einsum("bhsf->bhf", phi_k)
    num = torch.einsum("bhqf,bhfd->bhqd", phi_q, kv)
    den = torch.einsum("bhqf,bhf->bhq", phi_q, z)[..., None] + 1e-6
    o = num / den
    return (lambda x, *d: x.permute(*d))(o, 0, 2, 1, 3).reshape(B, S, D) @ wo
```

```asm
; @launch grid=(256,1,1) block=(512,1,1) lds=163840
.amdgcn_target "amdgcn-amd-amdhsa--gfx950"
.text
.globl standalone__linear_kernel_hedgehog__prompt_kernel
.p2align 8
.type standalone__linear_kernel_hedgehog__prompt_kernel,@function
standalone__linear_kernel_hedgehog__prompt_kernel:
    s_load_dwordx8 s[4:11], s[0:1], 0
    s_load_dwordx4 s[12:15], s[0:1], 32
    s_load_dwordx2 s[16:17], s[0:1], 48
    s_cmp_ge_u32 s2, 256
    s_cbranch_scc1 L_end
    v_lshrrev_b32 v1, 6, v0
    v_and_b32 v0, 63, v0
    s_and_b32 s40, s2, 7
    s_lshr_b32 s41, s2, 3
    v_readfirstlane_b32 s32, v1
    s_lshr_b32 s34, s40, 1
    s_lshl_b32 s34, s34, 2
    s_lshr_b32 s42, s41, 3
    s_add_u32 s34, s34, s42
    s_and_b32 s35, s40, 1
    s_lshl_b32 s35, s35, 3
    s_and_b32 s42, s41, 7
    s_add_u32 s35, s35, s42
    s_and_b32 s33, s32, 3
    s_mul_i32 s36, s35, 5
    s_and_b32 s36, s36, 7
    s_sub_u32 s36, 8, s36
    s_min_u32 s36, s36, 4
    s_mov_b32 s56, 0x3fb8aa3b
    s_mov_b32 s57, 0x3fb8aa3b
    s_and_b32 s40, s35, 7
    s_lshr_b32 s67, s40, 1
    s_lshr_b32 s66, 0x5a, s40
    s_and_b32 s66, s66, 1
    s_lshl_b32 s66, s66, 1
    s_lshr_b32 s40, s35, 3
    s_add_u32 s66, s66, s40
    s_cmp_ge_u32 s32, 4
    s_cbranch_scc1 L_lq
    s_lshl_b32 s40, s33, 6
    v_add_u32 v2, s40, v0
    s_mul_i32 s40, s2, 80
    s_mul_i32 s41, s2, 75
    s_mul_i32 s42, s2, 25
    s_sub_u32 s41, s41, 80
    s_sub_u32 s42, s42, 155
    s_waitcnt lgkmcnt(0)
    v_mov_b32 v3, s42
    v_mov_b32 v4, s10
    v_mov_b32 v5, s11
    v_mov_b32 v6, s41
    v_mov_b32 v7, s6
    v_mov_b32 v8, s7
    v_cmp_gt_u32 vcc, 155, v2
    s_nop 1
    v_cndmask_b32 v3, v3, v6, vcc
    v_cndmask_b32 v4, v4, v7, vcc
    v_cndmask_b32 v5, v5, v8, vcc
    v_mov_b32 v6, s40
    v_mov_b32 v7, s4
    v_mov_b32 v8, s5
    v_cmp_gt_u32 vcc, 80, v2
    s_nop 1
    v_cndmask_b32 v3, v3, v6, vcc
    v_cndmask_b32 v4, v4, v7, vcc
    v_cndmask_b32 v5, v5, v8, vcc
    v_add_u32 v3, v3, v2
    v_lshlrev_b32 v3, 7, v3
    v_add_co_u32 v4, vcc, v4, v3
    s_nop 1
    v_addc_co_u32 v5, vcc, 0, v5, vcc
    s_getpc_b64 s[44:45]
L_pc_ref:
    s_min_u32 s43, s2, (L_code_end-standalone__linear_kernel_hedgehog__prompt_kernel)/128
    s_lshl_b32 s43, s43, 7
    s_sub_u32 s44, s44, L_pc_ref-standalone__linear_kernel_hedgehog__prompt_kernel
    s_subb_u32 s45, s45, 0
    s_add_u32 s44, s44, s43
    s_addc_u32 s45, s45, 0
    s_min_u32 s43, s2, 199
    s_lshl_b32 s43, s43, 7
    s_add_u32 s46, s8, s43
    s_addc_u32 s47, s9, 0
    s_cmp_lg_u32 s33, 2
    s_cbranch_scc1 L_gpf_go
    v_writelane_b32 v4, s44, 52
    v_writelane_b32 v5, s45, 52
    v_writelane_b32 v4, s46, 53
    v_writelane_b32 v5, s47, 53
L_gpf_go:
    v_cmp_gt_u32 vcc, 182, v2
    s_nop 1
    s_and_saveexec_b64 s[40:41], vcc
    s_cbranch_execz L_gpf_done
    global_load_dword v48, v[4:5], off
L_gpf_done:
    s_mov_b64 exec, -1
    s_lshl_b32 s64, s35, 4
    s_add_u32 s64, s64, s34
    s_lshl_b32 s64, s64, 12
    s_add_u32 s64, s64, 0
    s_waitcnt lgkmcnt(0)
    s_mov_b32 s28, s16
    s_and_b32 s29, s17, 0xffff
    s_mov_b32 s30, 268435456
    s_mov_b32 s31, 0x20000
    s_mov_b32 s72, s14
    s_and_b32 s73, s15, 0xffff
    s_mov_b32 s74, 256
    s_mov_b32 s75, 0x20000
    s_or_b32 s40, s34, s35
    s_or_b32 s40, s40, s33
    s_cmp_lg_u32 s40, 0
    s_cbranch_scc1 L_kv_nn
    s_memrealtime s[44:45]
    s_waitcnt lgkmcnt(0)
    s_or_b32 s44, s44, 1
    v_mov_b32 v2, 0
    v_mov_b32 v3, s44
    s_mov_b64 exec, 1
    buffer_store_dword v3, v2, s[72:75], 0 offen sc1
    s_mov_b64 exec, -1
L_kv_nn:
    v_lshlrev_b32 v2, 4, v0
    s_lshl_b32 s40, s33, 10
    s_add_u32 s40, s40, 151552
    v_add_u32 v2, s40, v2
    v_mov_b32 v24, 0
    v_mov_b32 v25, 0
    v_mov_b32 v26, 0
    v_mov_b32 v27, 0
    s_cmp_eq_u32 s33, 3
    s_cbranch_scc1 L_kv_nz
    ds_write_b128 v2, v[24:27]
L_kv_nz:
    v_lshrrev_b32 v2, 4, v0
    v_bfe_u32 v3, v0, 2, 2
    v_and_b32 v4, 3, v0
    v_and_b32 v5, 1, v2
    v_lshlrev_b32 v5, 1, v5
    v_lshrrev_b32 v6, 1, v4
    v_add_u32 v5, v5, v6
    v_and_b32 v6, 1, v4
    v_lshlrev_b32 v5, 3, v5
    v_mul_u32_u24 v6, 5, v6
    v_lshrrev_b32 v7, 1, v2
    v_lshlrev_b32 v7, 3, v7
    v_add_u32 v7, v7, v3
    v_lshlrev_b32 v7, 8, v7
    v_add_u32 v7, 16384, v7
    v_lshlrev_b32 v8, 2, v3
    s_sub_u32 s41, 4, s36
    s_mov_b32 s40, 50462976
    v_bfe_u32 v18, s40, v5, 8
    v_add_u32 v18, v18, v6
    v_lshrrev_b32 v19, 1, v18
    v_mov_b32 v9, s41
    v_cmp_le_u32 vcc, s36, v19
    v_mov_b32 v20, 0
    s_nop 0
    v_cndmask_b32 v9, v20, v9, vcc
    v_add_u32 v19, v19, v9
    s_mov_b32 s40, 0
    v_bfe_u32 v9, s40, v5, 8
    v_add3_u32 v19, v19, v9, v8
    v_and_b32 v19, 15, v19
    v_lshlrev_b32 v19, 4, v19
    v_and_b32 v18, 1, v18
    v_lshlrev_b32 v18, 3, v18
    v_add3_u32 v10, v7, v19, v18
    s_mov_b32 s40, 33619972
    v_bfe_u32 v18, s40, v5, 8
    v_add_u32 v18, v18, v6
    v_lshrrev_b32 v19, 1, v18
    v_mov_b32 v9, s41
    v_cmp_le_u32 vcc, s36, v19
    v_mov_b32 v20, 0
    s_nop 0
    v_cndmask_b32 v9, v20, v9, vcc
    v_add_u32 v19, v19, v9
    s_mov_b32 s40, 134744064
    v_bfe_u32 v9, s40, v5, 8
    v_add3_u32 v19, v19, v9, v8
    v_and_b32 v19, 15, v19
    v_lshlrev_b32 v19, 4, v19
    v_and_b32 v18, 1, v18
    v_lshlrev_b32 v18, 3, v18
    v_add3_u32 v11, v7, v19, v18
    s_mov_b32 s40, 50529283
    v_bfe_u32 v18, s40, v5, 8
    v_add_u32 v18, v18, v6
    v_lshrrev_b32 v19, 1, v18
    v_mov_b32 v9, s41
    v_cmp_le_u32 vcc, s36, v19
    v_mov_b32 v20, 0
    s_nop 0
    v_cndmask_b32 v9, v20, v9, vcc
    v_add_u32 v19, v19, v9
    s_mov_b32 s40, 134744072
    v_bfe_u32 v9, s40, v5, 8
    v_add3_u32 v19, v19, v9, v8
    v_and_b32 v19, 15, v19
    v_lshlrev_b32 v19, 4, v19
    v_and_b32 v18, 1, v18
    v_lshlrev_b32 v18, 3, v18
    v_add3_u32 v12, v7, v19, v18
    v_and_b32 v2, 31, v0
    v_lshrrev_b32 v3, 5, v0
    v_bfe_u32 v4, v2, 1, 3
    v_xor_b32 v4, v4, v3
    v_lshlrev_b32 v4, 4, v4
    s_lshl_b32 s40, s33, 5
    v_add_u32 v2, s40, v2
    v_lshlrev_b32 v2, 7, v2
    v_add_u32 v14, v2, v4
    v_xor_b32 v15, 32, v14
    v_xor_b32 v16, 64, v14
    v_xor_b32 v17, 96, v14
    s_waitcnt lgkmcnt(0)
    s_barrier
    ds_read_b128 v[124:127], v14 offset:0
    ds_read_b64_tr_b16 v[112:113], v10 offset:0
    ds_read_b64_tr_b16 v[114:115], v10 offset:1024
    ds_read_b64_tr_b16 v[116:117], v11 offset:0
    ds_read_b64_tr_b16 v[118:119], v11 offset:1024
    ds_read_b64_tr_b16 v[120:121], v12 offset:0
    ds_read_b64_tr_b16 v[122:123], v12 offset:1024
    ds_read_b128 v[140:143], v15 offset:0
    ds_read_b64_tr_b16 v[128:129], v10 offset:4096
    ds_read_b64_tr_b16 v[130:131], v10 offset:5120
    ds_read_b64_tr_b16 v[132:133], v11 offset:4096
    ds_read_b64_tr_b16 v[134:135], v11 offset:5120
    ds_read_b64_tr_b16 v[136:137], v12 offset:4096
    ds_read_b64_tr_b16 v[138:139], v12 offset:5120
    s_waitcnt lgkmcnt(7)
    v_mfma_f32_32x32x16_bf16 v[64:79], v[112:115], v[124:127], 0
    v_mfma_f32_32x32x16_bf16 v[80:95], v[116:119], v[124:127], 0
    v_mfma_f32_32x32x16_bf16 v[96:111], v[120:123], v[124:127], 0
    ds_read_b128 v[124:127], v16 offset:0
    ds_read_b64_tr_b16 v[112:113], v10 offset:8192
    ds_read_b64_tr_b16 v[114:115], v10 offset:9216
    ds_read_b64_tr_b16 v[116:117], v11 offset:8192
    ds_read_b64_tr_b16 v[118:119], v11 offset:9216
    ds_read_b64_tr_b16 v[120:121], v12 offset:8192
    ds_read_b64_tr_b16 v[122:123], v12 offset:9216
    s_waitcnt lgkmcnt(7)
    v_mfma_f32_32x32x16_bf16 v[64:79], v[128:131], v[140:143], v[64:79]
    v_mfma_f32_32x32x16_bf16 v[80:95], v[132:135], v[140:143], v[80:95]
    v_mfma_f32_32x32x16_bf16 v[96:111], v[136:139], v[140:143], v[96:111]
    ds_read_b128 v[140:143], v17 offset:0
    ds_read_b64_tr_b16 v[128:129], v10 offset:12288
    ds_read_b64_tr_b16 v[130:131], v10 offset:13312
    ds_read_b64_tr_b16 v[132:133], v11 offset:12288
    ds_read_b64_tr_b16 v[134:135], v11 offset:13312
    ds_read_b64_tr_b16 v[136:137], v12 offset:12288
    ds_read_b64_tr_b16 v[138:139], v12 offset:13312
    s_waitcnt lgkmcnt(7)
    v_mfma_f32_32x32x16_bf16 v[64:79], v[112:115], v[124:127], v[64:79]
    v_mfma_f32_32x32x16_bf16 v[80:95], v[116:119], v[124:127], v[80:95]
    v_mfma_f32_32x32x16_bf16 v[96:111], v[120:123], v[124:127], v[96:111]
    v_mov_b32 v38, 0
    buffer_load_dword v39, v38, s[72:75], 0 offen sc1
    s_waitcnt lgkmcnt(0)
    s_barrier
    ds_read_b128 v[124:127], v14 offset:32768
    ds_read_b64_tr_b16 v[112:113], v10 offset:32768
    ds_read_b64_tr_b16 v[114:115], v10 offset:33792
    ds_read_b64_tr_b16 v[116:117], v11 offset:32768
    ds_read_b64_tr_b16 v[118:119], v11 offset:33792
    ds_read_b64_tr_b16 v[120:121], v12 offset:32768
    ds_read_b64_tr_b16 v[122:123], v12 offset:33792
    v_mfma_f32_32x32x16_bf16 v[64:79], v[128:131], v[140:143], v[64:79]
    v_mfma_f32_32x32x16_bf16 v[80:95], v[132:135], v[140:143], v[80:95]
    v_mfma_f32_32x32x16_bf16 v[96:111], v[136:139], v[140:143], v[96:111]
    ds_read_b128 v[140:143], v15 offset:32768
    ds_read_b64_tr_b16 v[128:129], v10 offset:36864
    ds_read_b64_tr_b16 v[130:131], v10 offset:37888
    ds_read_b64_tr_b16 v[132:133], v11 offset:36864
    ds_read_b64_tr_b16 v[134:135], v11 offset:37888
    ds_read_b64_tr_b16 v[136:137], v12 offset:36864
    ds_read_b64_tr_b16 v[138:139], v12 offset:37888
    s_waitcnt lgkmcnt(7)
    v_mfma_f32_32x32x16_bf16 v[64:79], v[112:115], v[124:127], v[64:79]
    v_mfma_f32_32x32x16_bf16 v[80:95], v[116:119], v[124:127], v[80:95]
    v_mfma_f32_32x32x16_bf16 v[96:111], v[120:123], v[124:127], v[96:111]
    ds_read_b128 v[124:127], v16 offset:32768
    ds_read_b64_tr_b16 v[112:113], v10 offset:40960
    ds_read_b64_tr_b16 v[114:115], v10 offset:41984
    ds_read_b64_tr_b16 v[116:117], v11 offset:40960
    ds_read_b64_tr_b16 v[118:119], v11 offset:41984
    ds_read_b64_tr_b16 v[120:121], v12 offset:40960
    ds_read_b64_tr_b16 v[122:123], v12 offset:41984
    s_waitcnt lgkmcnt(7)
    v_mfma_f32_32x32x16_bf16 v[64:79], v[128:131], v[140:143], v[64:79]
    v_mfma_f32_32x32x16_bf16 v[80:95], v[132:135], v[140:143], v[80:95]
    v_mfma_f32_32x32x16_bf16 v[96:111], v[136:139], v[140:143], v[96:111]
    ds_read_b128 v[140:143], v17 offset:32768
    ds_read_b64_tr_b16 v[128:129], v10 offset:45056
    ds_read_b64_tr_b16 v[130:131], v10 offset:46080
    ds_read_b64_tr_b16 v[132:133], v11 offset:45056
    ds_read_b64_tr_b16 v[134:135], v11 offset:46080
    ds_read_b64_tr_b16 v[136:137], v12 offset:45056
    ds_read_b64_tr_b16 v[138:139], v12 offset:46080
    s_waitcnt lgkmcnt(7)
    v_mfma_f32_32x32x16_bf16 v[64:79], v[112:115], v[124:127], v[64:79]
    v_mfma_f32_32x32x16_bf16 v[80:95], v[116:119], v[124:127], v[80:95]
    v_mfma_f32_32x32x16_bf16 v[96:111], v[120:123], v[124:127], v[96:111]
    v_lshrrev_b32 v22, 4, v0
    v_bfe_u32 v23, v0, 2, 2
    v_and_b32 v24, 3, v0
    v_and_b32 v25, 1, v22
    v_lshlrev_b32 v25, 1, v25
    v_lshrrev_b32 v26, 1, v24
    v_add_u32 v25, v25, v26
    v_and_b32 v26, 1, v24
    v_mul_u32_u24 v27, 800, v26
    v_mul_u32_u24 v28, 40, v23
    v_add_u32 v27, v27, v28
    v_lshlrev_b32 v28, 3, v25
    v_add_u32 v27, v27, v28
    v_add_u32 v27, 149504, v27
    v_lshrrev_b32 v28, 1, v22
    v_mov_b32 v19, 151552
    v_cmp_eq_u32 vcc, v28, v26
    s_nop 1
    v_cndmask_b32 v18, v19, v27, vcc
    v_cmp_eq_u32 s[58:59], 0, v25
    s_nop 1
    s_and_b64 vcc, vcc, s[58:59]
    v_add_u32 v27, 32, v27
    s_nop 0
    v_cndmask_b32 v19, v19, v27, vcc
    ds_read_b64_tr_b16 v[144:145], v18 offset:0
    ds_read_b64_tr_b16 v[146:147], v18 offset:160
    ds_read_b64_tr_b16 v[148:149], v18 offset:320
    ds_read_b64_tr_b16 v[150:151], v18 offset:480
    ds_read_b64_tr_b16 v[152:153], v18 offset:640
    v_mov_b32 v154, 0
    v_mov_b32 v155, 0
    ds_read_b64_tr_b16 v[156:157], v19 offset:0
    ds_read_b64_tr_b16 v[158:159], v19 offset:160
    ds_read_b64_tr_b16 v[160:161], v19 offset:320
    ds_read_b64_tr_b16 v[162:163], v19 offset:480
    ds_read_b64_tr_b16 v[164:165], v19 offset:640
    v_mov_b32 v166, 0
    v_mov_b32 v167, 0
    s_waitcnt lgkmcnt(0)
    s_barrier
    v_add_u32 v10, 65536, v10
    v_add_u32 v11, 65536, v11
    v_add_u32 v12, 65536, v12
    v_add_u32 v14, 65536, v14
    v_add_u32 v15, 65536, v15
    v_add_u32 v16, 65536, v16
    v_add_u32 v17, 65536, v17
    ds_read_b128 v[124:127], v14 offset:0
    ds_read_b64_tr_b16 v[112:113], v10 offset:0
    ds_read_b64_tr_b16 v[114:115], v10 offset:1024
    ds_read_b64_tr_b16 v[116:117], v11 offset:0
    ds_read_b64_tr_b16 v[118:119], v11 offset:1024
    ds_read_b64_tr_b16 v[120:121], v12 offset:0
    ds_read_b64_tr_b16 v[122:123], v12 offset:1024
    v_mfma_f32_32x32x16_bf16 v[64:79], v[128:131], v[140:143], v[64:79]
    v_mfma_f32_32x32x16_bf16 v[80:95], v[132:135], v[140:143], v[80:95]
    v_mfma_f32_32x32x16_bf16 v[96:111], v[136:139], v[140:143], v[96:111]
    ds_read_b128 v[140:143], v15 offset:0
    ds_read_b64_tr_b16 v[128:129], v10 offset:4096
    ds_read_b64_tr_b16 v[130:131], v10 offset:5120
    ds_read_b64_tr_b16 v[132:133], v11 offset:4096
    ds_read_b64_tr_b16 v[134:135], v11 offset:5120
    ds_read_b64_tr_b16 v[136:137], v12 offset:4096
    ds_read_b64_tr_b16 v[138:139], v12 offset:5120
    s_waitcnt lgkmcnt(7)
    v_mfma_f32_32x32x16_bf16 v[64:79], v[112:115], v[124:127], v[64:79]
    v_mfma_f32_32x32x16_bf16 v[80:95], v[116:119], v[124:127], v[80:95]
    v_mfma_f32_32x32x16_bf16 v[96:111], v[120:123], v[124:127], v[96:111]
    ds_read_b128 v[124:127], v16 offset:0
    ds_read_b64_tr_b16 v[112:113], v10 offset:8192
    ds_read_b64_tr_b16 v[114:115], v10 offset:9216
    ds_read_b64_tr_b16 v[116:117], v11 offset:8192
    ds_read_b64_tr_b16 v[118:119], v11 offset:9216
    ds_read_b64_tr_b16 v[120:121], v12 offset:8192
    ds_read_b64_tr_b16 v[122:123], v12 offset:9216
    s_waitcnt lgkmcnt(7)
    v_mfma_f32_32x32x16_bf16 v[64:79], v[128:131], v[140:143], v[64:79]
    v_mfma_f32_32x32x16_bf16 v[80:95], v[132:135], v[140:143], v[80:95]
    v_mfma_f32_32x32x16_bf16 v[96:111], v[136:139], v[140:143], v[96:111]
    ds_read_b128 v[140:143], v17 offset:0
    ds_read_b64_tr_b16 v[128:129], v10 offset:12288
    ds_read_b64_tr_b16 v[130:131], v10 offset:13312
    ds_read_b64_tr_b16 v[132:133], v11 offset:12288
    ds_read_b64_tr_b16 v[134:135], v11 offset:13312
    ds_read_b64_tr_b16 v[136:137], v12 offset:12288
    ds_read_b64_tr_b16 v[138:139], v12 offset:13312
    s_waitcnt lgkmcnt(7)
    v_mfma_f32_32x32x16_bf16 v[64:79], v[112:115], v[124:127], v[64:79]
    v_mfma_f32_32x32x16_bf16 v[80:95], v[116:119], v[124:127], v[80:95]
    v_mfma_f32_32x32x16_bf16 v[96:111], v[120:123], v[124:127], v[96:111]
    s_waitcnt vmcnt(0)
    v_readfirstlane_b32 s55, v39
    s_mov_b32 s60, 32768
    s_cmp_lg_u32 s55, 0
    s_cbranch_scc1 NF_1
NC_2:
    s_sub_u32 s60, s60, 1
    s_cbranch_scc1 L_end
    buffer_load_dword v39, v38, s[72:75], 0 offen sc1
    s_waitcnt vmcnt(0)
    v_readfirstlane_b32 s55, v39
    s_nop 0
    s_cmp_eq_u32 s55, 0
    s_cbranch_scc1 NC_2
NF_1:
    s_waitcnt lgkmcnt(0)
    s_barrier
    v_add_u32 v10, 4294901760, v10
    v_add_u32 v11, 4294901760, v11
    v_add_u32 v12, 4294901760, v12
    v_add_u32 v14, 4294901760, v14
    v_add_u32 v15, 4294901760, v15
    v_add_u32 v16, 4294901760, v16
    v_add_u32 v17, 4294901760, v17
    ds_read_b128 v[124:127], v14 offset:0
    ds_read_b64_tr_b16 v[112:113], v10 offset:0
    ds_read_b64_tr_b16 v[114:115], v10 offset:1024
    ds_read_b64_tr_b16 v[116:117], v11 offset:0
    ds_read_b64_tr_b16 v[118:119], v11 offset:1024
    ds_read_b64_tr_b16 v[120:121], v12 offset:0
    ds_read_b64_tr_b16 v[122:123], v12 offset:1024
    v_mfma_f32_32x32x16_bf16 v[64:79], v[128:131], v[140:143], v[64:79]
    v_mfma_f32_32x32x16_bf16 v[80:95], v[132:135], v[140:143], v[80:95]
    v_mfma_f32_32x32x16_bf16 v[96:111], v[136:139], v[140:143], v[96:111]
    ds_read_b128 v[140:143], v15 offset:0
    ds_read_b64_tr_b16 v[128:129], v10 offset:4096
    ds_read_b64_tr_b16 v[130:131], v10 offset:5120
    ds_read_b64_tr_b16 v[132:133], v11 offset:4096
    ds_read_b64_tr_b16 v[134:135], v11 offset:5120
    ds_read_b64_tr_b16 v[136:137], v12 offset:4096
    ds_read_b64_tr_b16 v[138:139], v12 offset:5120
    s_waitcnt lgkmcnt(7)
    v_mfma_f32_32x32x16_bf16 v[64:79], v[112:115], v[124:127], v[64:79]
    v_mfma_f32_32x32x16_bf16 v[80:95], v[116:119], v[124:127], v[80:95]
    v_mfma_f32_32x32x16_bf16 v[96:111], v[120:123], v[124:127], v[96:111]
    ds_read_b128 v[124:127], v16 offset:0
    ds_read_b64_tr_b16 v[112:113], v10 offset:8192
    ds_read_b64_tr_b16 v[114:115], v10 offset:9216
    ds_read_b64_tr_b16 v[116:117], v11 offset:8192
    ds_read_b64_tr_b16 v[118:119], v11 offset:9216
    ds_read_b64_tr_b16 v[120:121], v12 offset:8192
    ds_read_b64_tr_b16 v[122:123], v12 offset:9216
    s_waitcnt lgkmcnt(7)
    v_mfma_f32_32x32x16_bf16 v[64:79], v[128:131], v[140:143], v[64:79]
    v_mfma_f32_32x32x16_bf16 v[80:95], v[132:135], v[140:143], v[80:95]
    v_mfma_f32_32x32x16_bf16 v[96:111], v[136:139], v[140:143], v[96:111]
    ds_read_b128 v[140:143], v17 offset:0
    ds_read_b64_tr_b16 v[128:129], v10 offset:12288
    ds_read_b64_tr_b16 v[130:131], v10 offset:13312
    ds_read_b64_tr_b16 v[132:133], v11 offset:12288
    ds_read_b64_tr_b16 v[134:135], v11 offset:13312
    ds_read_b64_tr_b16 v[136:137], v12 offset:12288
    ds_read_b64_tr_b16 v[138:139], v12 offset:13312
    s_waitcnt lgkmcnt(7)
    v_mfma_f32_32x32x16_bf16 v[64:79], v[112:115], v[124:127], v[64:79]
    v_mfma_f32_32x32x16_bf16 v[80:95], v[116:119], v[124:127], v[80:95]
    v_mfma_f32_32x32x16_bf16 v[96:111], v[120:123], v[124:127], v[96:111]
    s_cmp_lg_u32 s33, 0
    s_cbranch_scc1 RD_3
    s_add_u32 s40, s64, 3840
    v_mov_b32 v2, 0
    v_mov_b32 v3, s55
    s_mov_b64 exec, 1
    buffer_store_dword v3, v2, s[28:31], s40 offen sc1
    s_mov_b64 exec, -1
RD_3:
    s_waitcnt lgkmcnt(0)
    s_barrier
    ds_read_b128 v[124:127], v14 offset:32768
    ds_read_b64_tr_b16 v[112:113], v10 offset:32768
    ds_read_b64_tr_b16 v[114:115], v10 offset:33792
    ds_read_b64_tr_b16 v[116:117], v11 offset:32768
    ds_read_b64_tr_b16 v[118:119], v11 offset:33792
    ds_read_b64_tr_b16 v[120:121], v12 offset:32768
    ds_read_b64_tr_b16 v[122:123], v12 offset:33792
    v_mfma_f32_32x32x16_bf16 v[64:79], v[128:131], v[140:143], v[64:79]
    v_mfma_f32_32x32x16_bf16 v[80:95], v[132:135], v[140:143], v[80:95]
    v_mfma_f32_32x32x16_bf16 v[96:111], v[136:139], v[140:143], v[96:111]
    ds_read_b128 v[140:143], v15 offset:32768
    ds_read_b64_tr_b16 v[128:129], v10 offset:36864
    ds_read_b64_tr_b16 v[130:131], v10 offset:37888
    ds_read_b64_tr_b16 v[132:133], v11 offset:36864
    ds_read_b64_tr_b16 v[134:135], v11 offset:37888
    ds_read_b64_tr_b16 v[136:137], v12 offset:36864
    ds_read_b64_tr_b16 v[138:139], v12 offset:37888
    s_waitcnt lgkmcnt(7)
    v_mfma_f32_32x32x16_bf16 v[64:79], v[112:115], v[124:127], v[64:79]
    v_mfma_f32_32x32x16_bf16 v[80:95], v[116:119], v[124:127], v[80:95]
    v_mfma_f32_32x32x16_bf16 v[96:111], v[120:123], v[124:127], v[96:111]
    ds_read_b128 v[124:127], v16 offset:32768
    ds_read_b64_tr_b16 v[112:113], v10 offset:40960
    ds_read_b64_tr_b16 v[114:115], v10 offset:41984
    ds_read_b64_tr_b16 v[116:117], v11 offset:40960
    ds_read_b64_tr_b16 v[118:119], v11 offset:41984
    ds_read_b64_tr_b16 v[120:121], v12 offset:40960
    ds_read_b64_tr_b16 v[122:123], v12 offset:41984
    s_waitcnt lgkmcnt(7)
    v_mfma_f32_32x32x16_bf16 v[64:79], v[128:131], v[140:143], v[64:79]
    v_mfma_f32_32x32x16_bf16 v[80:95], v[132:135], v[140:143], v[80:95]
    v_mfma_f32_32x32x16_bf16 v[96:111], v[136:139], v[140:143], v[96:111]
    ds_read_b128 v[140:143], v17 offset:32768
    ds_read_b64_tr_b16 v[128:129], v10 offset:45056
    ds_read_b64_tr_b16 v[130:131], v10 offset:46080
    ds_read_b64_tr_b16 v[132:133], v11 offset:45056
    ds_read_b64_tr_b16 v[134:135], v11 offset:46080
    ds_read_b64_tr_b16 v[136:137], v12 offset:45056
    ds_read_b64_tr_b16 v[138:139], v12 offset:46080
    s_waitcnt lgkmcnt(7)
    v_mfma_f32_32x32x16_bf16 v[64:79], v[112:115], v[124:127], v[64:79]
    v_mfma_f32_32x32x16_bf16 v[80:95], v[116:119], v[124:127], v[80:95]
    v_mfma_f32_32x32x16_bf16 v[96:111], v[120:123], v[124:127], v[96:111]
    v_and_b32 v2, 31, v0
    v_lshrrev_b32 v3, 5, v0
    v_lshlrev_b32 v3, 14, v3
    s_lshl_b32 s40, s33, 5
    v_add_u32 v2, s40, v2
    v_lshlrev_b32 v2, 7, v2
    v_add_u32 v2, v2, v3
    v_add_u32 v2, 32768, v2
    v_and_b32 v3, 7, v0
    v_bfe_u32 v4, v0, 3, 1
    v_lshlrev_b32 v4, 2, v4
    v_xor_b32 v3, v3, v4
    v_lshlrev_b32 v3, 4, v3
    v_add_u32 v18, v2, v3
    v_xor_b32 v19, 16, v18
    v_xor_b32 v20, 32, v18
    v_xor_b32 v21, 48, v18
    v_xor_b32 v22, 64, v18
    v_xor_b32 v23, 80, v18
    v_xor_b32 v24, 96, v18
    v_xor_b32 v25, 112, v18
    s_waitcnt lgkmcnt(0)
    s_barrier
    v_add_u32 v10, 65536, v10
    v_add_u32 v11, 65536, v11
    v_add_u32 v12, 65536, v12
    v_add_u32 v14, 65536, v14
    v_add_u32 v15, 65536, v15
    v_add_u32 v16, 65536, v16
    v_add_u32 v17, 65536, v17
    ds_read_b128 v[124:127], v14 offset:0
    ds_read_b64_tr_b16 v[112:113], v10 offset:0
    ds_read_b64_tr_b16 v[114:115], v10 offset:1024
    ds_read_b64_tr_b16 v[116:117], v11 offset:0
    ds_read_b64_tr_b16 v[118:119], v11 offset:1024
    ds_read_b64_tr_b16 v[120:121], v12 offset:0
    ds_read_b64_tr_b16 v[122:123], v12 offset:1024
    v_mfma_f32_32x32x16_bf16 v[64:79], v[128:131], v[140:143], v[64:79]
    v_mfma_f32_32x32x16_bf16 v[80:95], v[132:135], v[140:143], v[80:95]
    v_mfma_f32_32x32x16_bf16 v[96:111], v[136:139], v[140:143], v[96:111]
    ds_read_b128 v[140:143], v15 offset:0
    ds_read_b64_tr_b16 v[128:129], v10 offset:4096
    ds_read_b64_tr_b16 v[130:131], v10 offset:5120
    ds_read_b64_tr_b16 v[132:133], v11 offset:4096
    ds_read_b64_tr_b16 v[134:135], v11 offset:5120
    ds_read_b64_tr_b16 v[136:137], v12 offset:4096
    ds_read_b64_tr_b16 v[138:139], v12 offset:5120
    s_waitcnt lgkmcnt(7)
    v_mfma_f32_32x32x16_bf16 v[64:79], v[112:115], v[124:127], v[64:79]
    v_mfma_f32_32x32x16_bf16 v[80:95], v[116:119], v[124:127], v[80:95]
    v_mfma_f32_32x32x16_bf16 v[96:111], v[120:123], v[124:127], v[96:111]
    ds_read_b128 v[124:127], v16 offset:0
    ds_read_b64_tr_b16 v[112:113], v10 offset:8192
    ds_read_b64_tr_b16 v[114:115], v10 offset:9216
    ds_read_b64_tr_b16 v[116:117], v11 offset:8192
    ds_read_b64_tr_b16 v[118:119], v11 offset:9216
    ds_read_b64_tr_b16 v[120:121], v12 offset:8192
    ds_read_b64_tr_b16 v[122:123], v12 offset:9216
    s_waitcnt lgkmcnt(7)
    v_mfma_f32_32x32x16_bf16 v[64:79], v[128:131], v[140:143], v[64:79]
    v_mfma_f32_32x32x16_bf16 v[80:95], v[132:135], v[140:143], v[80:95]
    v_mfma_f32_32x32x16_bf16 v[96:111], v[136:139], v[140:143], v[96:111]
    ds_read_b128 v[140:143], v17 offset:0
    ds_read_b64_tr_b16 v[128:129], v10 offset:12288
    ds_read_b64_tr_b16 v[130:131], v10 offset:13312
    ds_read_b64_tr_b16 v[132:133], v11 offset:12288
    ds_read_b64_tr_b16 v[134:135], v11 offset:13312
    ds_read_b64_tr_b16 v[136:137], v12 offset:12288
    ds_read_b64_tr_b16 v[138:139], v12 offset:13312
    s_waitcnt lgkmcnt(7)
    v_mfma_f32_32x32x16_bf16 v[64:79], v[112:115], v[124:127], v[64:79]
    v_mfma_f32_32x32x16_bf16 v[80:95], v[116:119], v[124:127], v[80:95]
    v_mfma_f32_32x32x16_bf16 v[96:111], v[120:123], v[124:127], v[96:111]
    v_lshrrev_b32 v2, 4, v0
    v_bfe_u32 v3, v0, 2, 2
    v_and_b32 v4, 3, v0
    v_lshlrev_b32 v5, 3, v2
    v_add_u32 v5, v5, v3
    v_lshlrev_b32 v5, 7, v5
    s_lshr_b32 s40, s33, 1
    s_lshl_b32 s40, s40, 14
    s_add_u32 s40, s40, 32768
    v_add_u32 v5, s40, v5
    v_and_b32 v6, 1, v2
    v_lshlrev_b32 v6, 2, v6
    v_xor_b32 v6, v6, v3
    v_lshrrev_b32 v7, 1, v4
    v_and_b32 v8, 1, v4
    v_lshlrev_b32 v8, 3, v8
    v_add_u32 v5, v5, v8
    s_and_b32 s41, s33, 1
    v_add_u32 v9, 5, v7
    v_mov_b32 v40, 7
    s_cmp_eq_u32 s41, 1
    s_cselect_b64 vcc, -1, 0
    v_cndmask_b32 v9, v9, v40, vcc
    v_xor_b32 v9, v9, v6
    v_lshlrev_b32 v9, 4, v9
    v_add_u32 v26, v5, v9
    v_xor_b32 v27, 64, v26
    v_add_u32 v27, 512, v27
    v_add_u32 v9, 0, v7
    v_xor_b32 v9, v9, v6
    v_lshlrev_b32 v9, 4, v9
    v_add_u32 v28, v5, v9
    v_xor_b32 v29, 64, v28
    v_add_u32 v29, 512, v29
    v_add_u32 v9, 2, v7
    v_xor_b32 v9, v9, v6
    v_lshlrev_b32 v9, 4, v9
    v_add_u32 v30, v5, v9
    v_xor_b32 v31, 64, v30
    v_add_u32 v31, 512, v31
    v_mov_b32 v9, 4
    v_xor_b32 v9, v9, v6
    v_lshlrev_b32 v9, 4, v9
    v_add_u32 v32, v5, v9
    v_xor_b32 v33, 64, v32
    v_add_u32 v33, 512, v33
    v_lshrrev_b32 v2, 4, v0
    v_and_b32 v3, 15, v0
    s_lshr_b32 s40, s33, 1
    s_mul_i32 s40, s40, 6
    s_and_b32 s41, s33, 1
    s_lshl_b32 s42, s41, 2
    s_add_u32 s40, s40, s42
    v_add_u32 v4, s40, v2
    v_mul_u32_u24 v4, 40, v4
    v_add_u32 v4, v4, v3
    v_lshlrev_b32 v4, 3, v4
    v_mov_b32 v5, 0x40000000
    s_lshl_b32 s42, s41, 1
    s_sub_u32 s42, 4, s42
    v_cmp_gt_u32 vcc, s42, v2
    s_nop 1
    v_cndmask_b32 v34, v5, v4, vcc
    v_cmp_gt_u32 vcc, 8, v3
    s_nop 1
    v_cndmask_b32 v35, v5, v34, vcc
    s_waitcnt lgkmcnt(0)
    s_barrier
    v_add_u32 v10, 4294901760, v10
    v_add_u32 v11, 4294901760, v11
    v_add_u32 v12, 4294901760, v12
    v_add_u32 v14, 4294901760, v14
    v_add_u32 v15, 4294901760, v15
    v_add_u32 v16, 4294901760, v16
    v_add_u32 v17, 4294901760, v17
    ds_read_b128 v[124:127], v14 offset:0
    ds_read_b64_tr_b16 v[112:113], v10 offset:0
    ds_read_b64_tr_b16 v[114:115], v10 offset:1024
    ds_read_b64_tr_b16 v[116:117], v11 offset:0
    ds_read_b64_tr_b16 v[118:119], v11 offset:1024
    ds_read_b64_tr_b16 v[120:121], v12 offset:0
    ds_read_b64_tr_b16 v[122:123], v12 offset:1024
    v_mfma_f32_32x32x16_bf16 v[64:79], v[128:131], v[140:143], v[64:79]
    v_mfma_f32_32x32x16_bf16 v[80:95], v[132:135], v[140:143], v[80:95]
    v_mfma_f32_32x32x16_bf16 v[96:111], v[136:139], v[140:143], v[96:111]
    ds_read_b128 v[140:143], v15 offset:0
    ds_read_b64_tr_b16 v[128:129], v10 offset:4096
    ds_read_b64_tr_b16 v[130:131], v10 offset:5120
    ds_read_b64_tr_b16 v[132:133], v11 offset:4096
    ds_read_b64_tr_b16 v[134:135], v11 offset:5120
    ds_read_b64_tr_b16 v[136:137], v12 offset:4096
    ds_read_b64_tr_b16 v[138:139], v12 offset:5120
    s_waitcnt lgkmcnt(7)
    v_mfma_f32_32x32x16_bf16 v[64:79], v[112:115], v[124:127], v[64:79]
    v_mfma_f32_32x32x16_bf16 v[80:95], v[116:119], v[124:127], v[80:95]
    v_mfma_f32_32x32x16_bf16 v[96:111], v[120:123], v[124:127], v[96:111]
    ds_read_b128 v[124:127], v16 offset:0
    ds_read_b64_tr_b16 v[112:113], v10 offset:8192
    ds_read_b64_tr_b16 v[114:115], v10 offset:9216
    ds_read_b64_tr_b16 v[116:117], v11 offset:8192
    ds_read_b64_tr_b16 v[118:119], v11 offset:9216
    ds_read_b64_tr_b16 v[120:121], v12 offset:8192
    ds_read_b64_tr_b16 v[122:123], v12 offset:9216
    s_waitcnt lgkmcnt(7)
    v_mfma_f32_32x32x16_bf16 v[64:79], v[128:131], v[140:143], v[64:79]
    v_mfma_f32_32x32x16_bf16 v[80:95], v[132:135], v[140:143], v[80:95]
    v_mfma_f32_32x32x16_bf16 v[96:111], v[136:139], v[140:143], v[96:111]
    ds_read_b128 v[140:143], v17 offset:0
    ds_read_b64_tr_b16 v[128:129], v10 offset:12288
    ds_read_b64_tr_b16 v[130:131], v10 offset:13312
    ds_read_b64_tr_b16 v[132:133], v11 offset:12288
    ds_read_b64_tr_b16 v[134:135], v11 offset:13312
    ds_read_b64_tr_b16 v[136:137], v12 offset:12288
    ds_read_b64_tr_b16 v[138:139], v12 offset:13312
    s_waitcnt lgkmcnt(7)
    v_mfma_f32_32x32x16_bf16 v[64:79], v[112:115], v[124:127], v[64:79]
    v_mfma_f32_32x32x16_bf16 v[80:95], v[116:119], v[124:127], v[80:95]
    v_mfma_f32_32x32x16_bf16 v[96:111], v[120:123], v[124:127], v[96:111]
    s_waitcnt lgkmcnt(0)
    s_barrier
    ds_read_b128 v[124:127], v14 offset:32768
    ds_read_b64_tr_b16 v[112:113], v10 offset:32768
    ds_read_b64_tr_b16 v[114:115], v10 offset:33792
    ds_read_b64_tr_b16 v[116:117], v11 offset:32768
    ds_read_b64_tr_b16 v[118:119], v11 offset:33792
    ds_read_b64_tr_b16 v[120:121], v12 offset:32768
    ds_read_b64_tr_b16 v[122:123], v12 offset:33792
    v_mfma_f32_32x32x16_bf16 v[64:79], v[128:131], v[140:143], v[64:79]
    v_mfma_f32_32x32x16_bf16 v[80:95], v[132:135], v[140:143], v[80:95]
    v_mfma_f32_32x32x16_bf16 v[96:111], v[136:139], v[140:143], v[96:111]
    ds_read_b128 v[140:143], v15 offset:32768
    ds_read_b64_tr_b16 v[128:129], v10 offset:36864
    ds_read_b64_tr_b16 v[130:131], v10 offset:37888
    ds_read_b64_tr_b16 v[132:133], v11 offset:36864
    ds_read_b64_tr_b16 v[134:135], v11 offset:37888
    ds_read_b64_tr_b16 v[136:137], v12 offset:36864
    ds_read_b64_tr_b16 v[138:139], v12 offset:37888
    s_waitcnt lgkmcnt(7)
    v_mfma_f32_32x32x16_bf16 v[64:79], v[112:115], v[124:127], v[64:79]
    v_mfma_f32_32x32x16_bf16 v[80:95], v[116:119], v[124:127], v[80:95]
    v_mfma_f32_32x32x16_bf16 v[96:111], v[120:123], v[124:127], v[96:111]
    ds_read_b128 v[124:127], v16 offset:32768
    ds_read_b64_tr_b16 v[112:113], v10 offset:40960
    ds_read_b64_tr_b16 v[114:115], v10 offset:41984
    ds_read_b64_tr_b16 v[116:117], v11 offset:40960
    ds_read_b64_tr_b16 v[118:119], v11 offset:41984
    ds_read_b64_tr_b16 v[120:121], v12 offset:40960
    ds_read_b64_tr_b16 v[122:123], v12 offset:41984
    s_waitcnt lgkmcnt(7)
    v_mfma_f32_32x32x16_bf16 v[64:79], v[128:131], v[140:143], v[64:79]
    v_mfma_f32_32x32x16_bf16 v[80:95], v[132:135], v[140:143], v[80:95]
    v_mfma_f32_32x32x16_bf16 v[96:111], v[136:139], v[140:143], v[96:111]
    ds_read_b128 v[140:143], v17 offset:32768
    ds_read_b64_tr_b16 v[128:129], v10 offset:45056
    ds_read_b64_tr_b16 v[130:131], v10 offset:46080
    ds_read_b64_tr_b16 v[132:133], v11 offset:45056
    ds_read_b64_tr_b16 v[134:135], v11 offset:46080
    ds_read_b64_tr_b16 v[136:137], v12 offset:45056
    ds_read_b64_tr_b16 v[138:139], v12 offset:46080
    s_waitcnt lgkmcnt(7)
    v_mfma_f32_32x32x16_bf16 v[64:79], v[112:115], v[124:127], v[64:79]
    v_mfma_f32_32x32x16_bf16 v[80:95], v[116:119], v[124:127], v[80:95]
    v_mfma_f32_32x32x16_bf16 v[96:111], v[120:123], v[124:127], v[96:111]
    v_and_b32 v2, 15, v0
    s_lshl_b32 s40, s35, 4
    v_add_u32 v3, s40, v2
    v_lshlrev_b32 v4, 4, v2
    v_add_u32 v4, s34, v4
    v_bfe_u32 v5, v0, 4, 1
    v_cmp_eq_u32 vcc, 0, v5
    s_mov_b32 s41, 3840
    s_nop 0
    v_cndmask_b32 v3, v4, v3, vcc
    v_lshlrev_b32 v42, 12, v3
    buffer_load_dword v43, v42, s[28:31], s41 offen sc1
    s_waitcnt lgkmcnt(0)
    s_barrier
    v_add_u32 v10, 65536, v10
    v_add_u32 v11, 65536, v11
    v_add_u32 v12, 65536, v12
    v_add_u32 v14, 65536, v14
    v_add_u32 v15, 65536, v15
    v_add_u32 v16, 65536, v16
    v_add_u32 v17, 65536, v17
    ds_read_b128 v[124:127], v14 offset:0
    ds_read_b64_tr_b16 v[112:113], v10 offset:0
    ds_read_b64_tr_b16 v[114:115], v10 offset:1024
    ds_read_b64_tr_b16 v[116:117], v11 offset:0
    ds_read_b64_tr_b16 v[118:119], v11 offset:1024
    ds_read_b64_tr_b16 v[120:121], v12 offset:0
    ds_read_b64_tr_b16 v[122:123], v12 offset:1024
    v_mfma_f32_32x32x16_bf16 v[64:79], v[128:131], v[140:143], v[64:79]
    v_mfma_f32_32x32x16_bf16 v[80:95], v[132:135], v[140:143], v[80:95]
    v_mfma_f32_32x32x16_bf16 v[96:111], v[136:139], v[140:143], v[96:111]
    ds_read_b128 v[140:143], v15 offset:0
    ds_read_b64_tr_b16 v[128:129], v10 offset:4096
    ds_read_b64_tr_b16 v[130:131], v10 offset:5120
    ds_read_b64_tr_b16 v[132:133], v11 offset:4096
    ds_read_b64_tr_b16 v[134:135], v11 offset:5120
    ds_read_b64_tr_b16 v[136:137], v12 offset:4096
    ds_read_b64_tr_b16 v[138:139], v12 offset:5120
    s_waitcnt lgkmcnt(7)
    v_mfma_f32_32x32x16_bf16 v[64:79], v[112:115], v[124:127], v[64:79]
    v_mfma_f32_32x32x16_bf16 v[80:95], v[116:119], v[124:127], v[80:95]
    v_mfma_f32_32x32x16_bf16 v[96:111], v[120:123], v[124:127], v[96:111]
    ds_read_b128 v[124:127], v16 offset:0
    ds_read_b64_tr_b16 v[112:113], v10 offset:8192
    ds_read_b64_tr_b16 v[114:115], v10 offset:9216
    ds_read_b64_tr_b16 v[116:117], v11 offset:8192
    ds_read_b64_tr_b16 v[118:119], v11 offset:9216
    ds_read_b64_tr_b16 v[120:121], v12 offset:8192
    ds_read_b64_tr_b16 v[122:123], v12 offset:9216
    s_waitcnt lgkmcnt(7)
    v_mfma_f32_32x32x16_bf16 v[64:79], v[128:131], v[140:143], v[64:79]
    v_mfma_f32_32x32x16_bf16 v[80:95], v[132:135], v[140:143], v[80:95]
    v_mfma_f32_32x32x16_bf16 v[96:111], v[136:139], v[140:143], v[96:111]
    ds_read_b128 v[140:143], v17 offset:0
    ds_read_b64_tr_b16 v[128:129], v10 offset:12288
    ds_read_b64_tr_b16 v[130:131], v10 offset:13312
    ds_read_b64_tr_b16 v[132:133], v11 offset:12288
    ds_read_b64_tr_b16 v[134:135], v11 offset:13312
    ds_read_b64_tr_b16 v[136:137], v12 offset:12288
    ds_read_b64_tr_b16 v[138:139], v12 offset:13312
    s_waitcnt lgkmcnt(7)
    v_mfma_f32_32x32x16_bf16 v[64:79], v[112:115], v[124:127], v[64:79]
    v_mfma_f32_32x32x16_bf16 v[80:95], v[116:119], v[124:127], v[80:95]
    v_mfma_f32_32x32x16_bf16 v[96:111], v[120:123], v[124:127], v[96:111]
    s_waitcnt lgkmcnt(0)
    s_barrier
    v_add_u32 v10, 4294901760, v10
    v_add_u32 v11, 4294901760, v11
    v_add_u32 v12, 4294901760, v12
    v_add_u32 v14, 4294901760, v14
    v_add_u32 v15, 4294901760, v15
    v_add_u32 v16, 4294901760, v16
    v_add_u32 v17, 4294901760, v17
    ds_read_b128 v[124:127], v14 offset:0
    ds_read_b64_tr_b16 v[112:113], v10 offset:0
    ds_read_b64_tr_b16 v[114:115], v10 offset:1024
    ds_read_b64_tr_b16 v[116:117], v11 offset:0
    ds_read_b64_tr_b16 v[118:119], v11 offset:1024
    ds_read_b64_tr_b16 v[120:121], v12 offset:0
    ds_read_b64_tr_b16 v[122:123], v12 offset:1024
    v_mfma_f32_32x32x16_bf16 v[64:79], v[128:131], v[140:143], v[64:79]
    v_mfma_f32_32x32x16_bf16 v[80:95], v[132:135], v[140:143], v[80:95]
    v_mfma_f32_32x32x16_bf16 v[96:111], v[136:139], v[140:143], v[96:111]
    ds_read_b128 v[140:143], v15 offset:0
    ds_read_b64_tr_b16 v[128:129], v10 offset:4096
    ds_read_b64_tr_b16 v[130:131], v10 offset:5120
    ds_read_b64_tr_b16 v[132:133], v11 offset:4096
    ds_read_b64_tr_b16 v[134:135], v11 offset:5120
    ds_read_b64_tr_b16 v[136:137], v12 offset:4096
    ds_read_b64_tr_b16 v[138:139], v12 offset:5120
    s_waitcnt lgkmcnt(7)
    v_mfma_f32_32x32x16_bf16 v[64:79], v[112:115], v[124:127], v[64:79]
    v_mfma_f32_32x32x16_bf16 v[80:95], v[116:119], v[124:127], v[80:95]
    v_mfma_f32_32x32x16_bf16 v[96:111], v[120:123], v[124:127], v[96:111]
    s_barrier
    ds_read_b128 v[124:127], v16 offset:0
    ds_read_b64_tr_b16 v[112:113], v10 offset:8192
    ds_read_b64_tr_b16 v[114:115], v10 offset:9216
    ds_read_b64_tr_b16 v[116:117], v11 offset:8192
    ds_read_b64_tr_b16 v[118:119], v11 offset:9216
    ds_read_b64_tr_b16 v[120:121], v12 offset:8192
    ds_read_b64_tr_b16 v[122:123], v12 offset:9216
    s_waitcnt lgkmcnt(7)
    v_mfma_f32_32x32x16_bf16 v[64:79], v[128:131], v[140:143], v[64:79]
    v_mfma_f32_32x32x16_bf16 v[80:95], v[132:135], v[140:143], v[80:95]
    v_mfma_f32_32x32x16_bf16 v[96:111], v[136:139], v[140:143], v[96:111]
    ds_read_b128 v[140:143], v17 offset:0
    ds_read_b64_tr_b16 v[128:129], v10 offset:12288
    ds_read_b64_tr_b16 v[130:131], v10 offset:13312
    ds_read_b64_tr_b16 v[132:133], v11 offset:12288
    ds_read_b64_tr_b16 v[134:135], v11 offset:13312
    ds_read_b64_tr_b16 v[136:137], v12 offset:12288
    ds_read_b64_tr_b16 v[138:139], v12 offset:13312
    s_waitcnt lgkmcnt(7)
    v_mfma_f32_32x32x16_bf16 v[64:79], v[112:115], v[124:127], v[64:79]
    v_mfma_f32_32x32x16_bf16 v[80:95], v[116:119], v[124:127], v[80:95]
    v_mfma_f32_32x32x16_bf16 v[96:111], v[120:123], v[124:127], v[96:111]
    s_waitcnt lgkmcnt(0)
    v_mfma_f32_32x32x16_bf16 v[64:79], v[128:131], v[140:143], v[64:79]
    v_mfma_f32_32x32x16_bf16 v[80:95], v[132:135], v[140:143], v[80:95]
    v_mfma_f32_32x32x16_bf16 v[96:111], v[136:139], v[140:143], v[96:111]
    s_nop 9
    v_cvt_pk_bf16_f32 v168, v64, v65
    v_cvt_pk_bf16_f32 v169, v66, v67
    v_cvt_pk_bf16_f32 v170, v68, v69
    v_cvt_pk_bf16_f32 v171, v70, v71
    v_cvt_pk_bf16_f32 v172, v72, v73
    v_cvt_pk_bf16_f32 v173, v74, v75
    v_cvt_pk_bf16_f32 v174, v76, v77
    v_cvt_pk_bf16_f32 v175, v78, v79
    v_cvt_pk_bf16_f32 v176, v80, v81
    v_cvt_pk_bf16_f32 v177, v82, v83
    v_mov_b32 v178, 0
    v_mov_b32 v179, 0
    s_nop 0
    v_mfma_f32_32x32x16_bf16 v[192:207], v[144:147], v[168:171], 0
    v_mfma_f32_32x32x16_bf16 v[208:223], v[156:159], v[168:171], 0
    v_mfma_f32_32x32x16_bf16 v[192:207], v[148:151], v[172:175], v[192:207]
    v_mfma_f32_32x32x16_bf16 v[208:223], v[160:163], v[172:175], v[208:223]
    v_mfma_f32_32x32x16_bf16 v[192:207], v[152:155], v[176:179], v[192:207]
    v_mfma_f32_32x32x16_bf16 v[208:223], v[164:167], v[176:179], v[208:223]
    v_cvt_pk_bf16_f32 v180, v84, v85
    v_cvt_pk_bf16_f32 v181, v86, v87
    v_cvt_pk_bf16_f32 v182, v88, v89
    v_cvt_pk_bf16_f32 v183, v90, v91
    v_cvt_pk_bf16_f32 v184, v92, v93
    v_cvt_pk_bf16_f32 v185, v94, v95
    v_cvt_pk_bf16_f32 v186, v96, v97
    v_cvt_pk_bf16_f32 v187, v98, v99
    v_cvt_pk_bf16_f32 v188, v100, v101
    v_cvt_pk_bf16_f32 v189, v102, v103
    v_mov_b32 v190, 0x3f80
    v_mov_b32 v191, 0
    ds_write_b128 v23, v[180:183]
    ds_write_b128 v24, v[184:187]
    ds_write_b128 v25, v[188:191]
    s_nop 7
    s_nop 3
    v_max3_f32 v244, v192, v193, v194
    v_min3_f32 v245, v192, v193, v194
    v_max3_f32 v244, v244, v195, v196
    v_min3_f32 v245, v245, v195, v196
    v_max3_f32 v244, v244, v197, v198
    v_min3_f32 v245, v245, v197, v198
    v_max3_f32 v244, v244, v199, v200
    v_min3_f32 v245, v245, v199, v200
    v_max3_f32 v244, v244, v201, v202
    v_min3_f32 v245, v245, v201, v202
    v_max3_f32 v244, v244, v203, v204
    v_min3_f32 v245, v245, v203, v204
    v_max3_f32 v244, v244, v205, v206
    v_min3_f32 v245, v245, v205, v206
    v_max3_f32 v244, v244, v207, v208
    v_min3_f32 v245, v245, v207, v208
    v_max3_f32 v244, v244, v209, v210
    v_min3_f32 v245, v245, v209, v210
    v_max_f32 v244, v244, v211
    v_min_f32 v245, v245, v211
    v_mul_f32 v246, 0xbfb8aa3b, v244
    v_mul_f32 v248, 0x3fb8aa3b, v245
    v_pk_fma_f32 v[224:225], v[192:193], s[56:57], v[246:247] op_sel_hi:[1,1,0]
    v_pk_fma_f32 v[112:113], v[192:193], s[56:57], v[248:249] op_sel_hi:[1,1,0] neg_lo:[1,0,0] neg_hi:[1,0,0]
    v_pk_fma_f32 v[226:227], v[194:195], s[56:57], v[246:247] op_sel_hi:[1,1,0]
    v_pk_fma_f32 v[114:115], v[194:195], s[56:57], v[248:249] op_sel_hi:[1,1,0] neg_lo:[1,0,0] neg_hi:[1,0,0]
    v_pk_fma_f32 v[228:229], v[196:197], s[56:57], v[246:247] op_sel_hi:[1,1,0]
    v_pk_fma_f32 v[116:117], v[196:197], s[56:57], v[248:249] op_sel_hi:[1,1,0] neg_lo:[1,0,0] neg_hi:[1,0,0]
    v_pk_fma_f32 v[230:231], v[198:199], s[56:57], v[246:247] op_sel_hi:[1,1,0]
    v_pk_fma_f32 v[118:119], v[198:199], s[56:57], v[248:249] op_sel_hi:[1,1,0] neg_lo:[1,0,0] neg_hi:[1,0,0]
    v_pk_fma_f32 v[232:233], v[200:201], s[56:57], v[246:247] op_sel_hi:[1,1,0]
    v_pk_fma_f32 v[120:121], v[200:201], s[56:57], v[248:249] op_sel_hi:[1,1,0] neg_lo:[1,0,0] neg_hi:[1,0,0]
    v_pk_fma_f32 v[234:235], v[202:203], s[56:57], v[246:247] op_sel_hi:[1,1,0]
    v_pk_fma_f32 v[122:123], v[202:203], s[56:57], v[248:249] op_sel_hi:[1,1,0] neg_lo:[1,0,0] neg_hi:[1,0,0]
    v_pk_fma_f32 v[236:237], v[204:205], s[56:57], v[246:247] op_sel_hi:[1,1,0]
    v_pk_fma_f32 v[124:125], v[204:205], s[56:57], v[248:249] op_sel_hi:[1,1,0] neg_lo:[1,0,0] neg_hi:[1,0,0]
    v_pk_fma_f32 v[238:239], v[206:207], s[56:57], v[246:247] op_sel_hi:[1,1,0]
    v_pk_fma_f32 v[126:127], v[206:207], s[56:57], v[248:249] op_sel_hi:[1,1,0] neg_lo:[1,0,0] neg_hi:[1,0,0]
    v_pk_fma_f32 v[240:241], v[208:209], s[56:57], v[246:247] op_sel_hi:[1,1,0]
    v_pk_fma_f32 v[128:129], v[208:209], s[56:57], v[248:249] op_sel_hi:[1,1,0] neg_lo:[1,0,0] neg_hi:[1,0,0]
    v_pk_fma_f32 v[242:243], v[210:211], s[56:57], v[246:247] op_sel_hi:[1,1,0]
    v_pk_fma_f32 v[130:131], v[210:211], s[56:57], v[248:249] op_sel_hi:[1,1,0] neg_lo:[1,0,0] neg_hi:[1,0,0]
    v_exp_f32 v224, v224
    v_exp_f32 v112, v112
    v_exp_f32 v225, v225
    v_exp_f32 v113, v113
    v_exp_f32 v226, v226
    v_exp_f32 v114, v114
    v_exp_f32 v227, v227
    v_exp_f32 v115, v115
    v_exp_f32 v228, v228
    v_exp_f32 v116, v116
    v_exp_f32 v229, v229
    v_exp_f32 v117, v117
    v_exp_f32 v230, v230
    v_exp_f32 v118, v118
    v_exp_f32 v231, v231
    v_exp_f32 v119, v119
    v_exp_f32 v232, v232
    v_exp_f32 v120, v120
    v_exp_f32 v233, v233
    v_exp_f32 v121, v121
    v_exp_f32 v234, v234
    v_exp_f32 v122, v122
    v_exp_f32 v235, v235
    v_exp_f32 v123, v123
    v_exp_f32 v236, v236
    v_exp_f32 v124, v124
    v_exp_f32 v237, v237
    v_exp_f32 v125, v125
    v_exp_f32 v238, v238
    v_exp_f32 v126, v126
    v_exp_f32 v239, v239
    v_exp_f32 v127, v127
    v_exp_f32 v240, v240
    v_exp_f32 v128, v128
    v_exp_f32 v241, v241
    v_exp_f32 v129, v129
    v_exp_f32 v242, v242
    v_exp_f32 v130, v130
    v_exp_f32 v243, v243
    v_exp_f32 v131, v131
    v_pk_add_f32 v[246:247], v[224:225], v[226:227]
    v_pk_add_f32 v[248:249], v[112:113], v[114:115]
    v_pk_add_f32 v[246:247], v[246:247], v[228:229]
    v_pk_add_f32 v[248:249], v[248:249], v[116:117]
    v_pk_add_f32 v[246:247], v[246:247], v[230:231]
    v_pk_add_f32 v[248:249], v[248:249], v[118:119]
    v_pk_add_f32 v[246:247], v[246:247], v[232:233]
    v_pk_add_f32 v[248:249], v[248:249], v[120:121]
    v_pk_add_f32 v[246:247], v[246:247], v[234:235]
    v_pk_add_f32 v[248:249], v[248:249], v[122:123]
    v_pk_add_f32 v[246:247], v[246:247], v[236:237]
    v_pk_add_f32 v[248:249], v[248:249], v[124:125]
    v_pk_add_f32 v[246:247], v[246:247], v[238:239]
    v_pk_add_f32 v[248:249], v[248:249], v[126:127]
    v_pk_add_f32 v[246:247], v[246:247], v[240:241]
    v_pk_add_f32 v[248:249], v[248:249], v[128:129]
    v_pk_add_f32 v[246:247], v[246:247], v[242:243]
    v_pk_add_f32 v[248:249], v[248:249], v[130:131]
    v_add_f32 v246, v246, v247
    v_add_f32 v248, v248, v249
    v_rcp_f32 v246, v246
    v_rcp_f32 v248, v248
    s_nop 0
    v_pk_mul_f32 v[224:225], v[224:225], v[246:247] op_sel_hi:[1,0]
    v_pk_mul_f32 v[112:113], v[112:113], v[248:249] op_sel_hi:[1,0]
    v_pk_mul_f32 v[226:227], v[226:227], v[246:247] op_sel_hi:[1,0]
    v_pk_mul_f32 v[114:115], v[114:115], v[248:249] op_sel_hi:[1,0]
    v_pk_mul_f32 v[228:229], v[228:229], v[246:247] op_sel_hi:[1,0]
    v_pk_mul_f32 v[116:117], v[116:117], v[248:249] op_sel_hi:[1,0]
    v_pk_mul_f32 v[230:231], v[230:231], v[246:247] op_sel_hi:[1,0]
    v_pk_mul_f32 v[118:119], v[118:119], v[248:249] op_sel_hi:[1,0]
    v_pk_mul_f32 v[232:233], v[232:233], v[246:247] op_sel_hi:[1,0]
    v_pk_mul_f32 v[120:121], v[120:121], v[248:249] op_sel_hi:[1,0]
    v_pk_mul_f32 v[234:235], v[234:235], v[246:247] op_sel_hi:[1,0]
    v_pk_mul_f32 v[122:123], v[122:123], v[248:249] op_sel_hi:[1,0]
    v_pk_mul_f32 v[236:237], v[236:237], v[246:247] op_sel_hi:[1,0]
    v_pk_mul_f32 v[124:125], v[124:125], v[248:249] op_sel_hi:[1,0]
    v_pk_mul_f32 v[238:239], v[238:239], v[246:247] op_sel_hi:[1,0]
    v_pk_mul_f32 v[126:127], v[126:127], v[248:249] op_sel_hi:[1,0]
    v_pk_mul_f32 v[240:241], v[240:241], v[246:247] op_sel_hi:[1,0]
    v_pk_mul_f32 v[128:129], v[128:129], v[248:249] op_sel_hi:[1,0]
    v_pk_mul_f32 v[242:243], v[242:243], v[246:247] op_sel_hi:[1,0]
    v_pk_mul_f32 v[130:131], v[130:131], v[248:249] op_sel_hi:[1,0]
    v_cvt_pk_bf16_f32 v64, v224, v225
    v_cvt_pk_bf16_f32 v74, v112, v113
    v_cvt_pk_bf16_f32 v65, v226, v227
    v_cvt_pk_bf16_f32 v75, v114, v115
    v_cvt_pk_bf16_f32 v66, v228, v229
    v_cvt_pk_bf16_f32 v76, v116, v117
    v_cvt_pk_bf16_f32 v67, v230, v231
    v_cvt_pk_bf16_f32 v77, v118, v119
    v_cvt_pk_bf16_f32 v68, v232, v233
    v_cvt_pk_bf16_f32 v78, v120, v121
    v_cvt_pk_bf16_f32 v69, v234, v235
    v_cvt_pk_bf16_f32 v79, v122, v123
    v_cvt_pk_bf16_f32 v70, v236, v237
    v_cvt_pk_bf16_f32 v80, v124, v125
    v_cvt_pk_bf16_f32 v71, v238, v239
    v_cvt_pk_bf16_f32 v81, v126, v127
    v_cvt_pk_bf16_f32 v72, v240, v241
    v_cvt_pk_bf16_f32 v82, v128, v129
    v_cvt_pk_bf16_f32 v73, v242, v243
    v_cvt_pk_bf16_f32 v83, v130, v131
    ds_write_b128 v18, v[64:67]
    ds_write_b128 v19, v[68:71]
    ds_write_b128 v20, v[72:75]
    ds_write_b128 v21, v[76:79]
    ds_write_b128 v22, v[80:83]
    v_mov_b32 v2, 153600
    v_mov_b32 v3, 1
    s_mov_b64 exec, 1
    ds_add_u32 v2, v3
    s_mov_b64 exec, -1
    v_mov_b32 v2, 153600
    s_mov_b32 s60, 524288
SW_4:
    s_sub_u32 s60, s60, 1
    s_cbranch_scc1 L_end
    ds_read_b32 v3, v2
    s_waitcnt lgkmcnt(0)
    v_readfirstlane_b32 s40, v3
    s_nop 0
    s_cmp_lt_u32 s40, 4
    s_cbranch_scc1 SW_4
    ds_read_b64_tr_b16 v[64:65], v26 offset:0
    ds_read_b64_tr_b16 v[66:67], v27 offset:0
    ds_read_b64_tr_b16 v[68:69], v28 offset:0
    ds_read_b64_tr_b16 v[70:71], v29 offset:0
    ds_read_b64_tr_b16 v[72:73], v30 offset:0
    ds_read_b64_tr_b16 v[74:75], v31 offset:0
    ds_read_b64_tr_b16 v[76:77], v32 offset:0
    ds_read_b64_tr_b16 v[78:79], v33 offset:0
    ds_read_b64_tr_b16 v[80:81], v26 offset:4096
    ds_read_b64_tr_b16 v[82:83], v27 offset:4096
    ds_read_b64_tr_b16 v[84:85], v28 offset:4096
    ds_read_b64_tr_b16 v[86:87], v29 offset:4096
    ds_read_b64_tr_b16 v[88:89], v30 offset:4096
    ds_read_b64_tr_b16 v[90:91], v31 offset:4096
    ds_read_b64_tr_b16 v[92:93], v32 offset:4096
    ds_read_b64_tr_b16 v[94:95], v33 offset:4096
    ds_read_b64_tr_b16 v[96:97], v26 offset:8192
    ds_read_b64_tr_b16 v[98:99], v27 offset:8192
    ds_read_b64_tr_b16 v[100:101], v28 offset:8192
    ds_read_b64_tr_b16 v[102:103], v29 offset:8192
    ds_read_b64_tr_b16 v[104:105], v30 offset:8192
    ds_read_b64_tr_b16 v[106:107], v31 offset:8192
    ds_read_b64_tr_b16 v[108:109], v32 offset:8192
    ds_read_b64_tr_b16 v[110:111], v33 offset:8192
    ds_read_b64_tr_b16 v[112:113], v26 offset:12288
    ds_read_b64_tr_b16 v[114:115], v27 offset:12288
    ds_read_b64_tr_b16 v[116:117], v28 offset:12288
    ds_read_b64_tr_b16 v[118:119], v29 offset:12288
    ds_read_b64_tr_b16 v[120:121], v30 offset:12288
    ds_read_b64_tr_b16 v[122:123], v31 offset:12288
    ds_read_b64_tr_b16 v[124:125], v32 offset:12288
    ds_read_b64_tr_b16 v[126:127], v33 offset:12288
    s_waitcnt lgkmcnt(15)
    v_mfma_f32_16x16x32_bf16 v[192:195], v[64:67], v[68:71], 0
    v_mfma_f32_16x16x32_bf16 v[196:199], v[64:67], v[72:75], 0
    v_mfma_f32_16x16x32_bf16 v[200:203], v[64:67], v[76:79], 0
    s_waitcnt lgkmcnt(15)
    v_mfma_f32_16x16x32_bf16 v[192:195], v[80:83], v[84:87], v[192:195]
    v_mfma_f32_16x16x32_bf16 v[196:199], v[80:83], v[88:91], v[196:199]
    v_mfma_f32_16x16x32_bf16 v[200:203], v[80:83], v[92:95], v[200:203]
    s_waitcnt lgkmcnt(8)
    v_mfma_f32_16x16x32_bf16 v[192:195], v[96:99], v[100:103], v[192:195]
    v_mfma_f32_16x16x32_bf16 v[196:199], v[96:99], v[104:107], v[196:199]
    v_mfma_f32_16x16x32_bf16 v[200:203], v[96:99], v[108:111], v[200:203]
    s_waitcnt lgkmcnt(0)
    v_mfma_f32_16x16x32_bf16 v[192:195], v[112:115], v[116:119], v[192:195]
    v_mfma_f32_16x16x32_bf16 v[196:199], v[112:115], v[120:123], v[196:199]
    v_mfma_f32_16x16x32_bf16 v[200:203], v[112:115], v[124:127], v[200:203]
    v_mov_b32 v2, 153604
    v_mov_b32 v3, 1
    s_mov_b64 exec, 1
    ds_add_u32 v2, v3
    s_mov_b64 exec, -1
    s_nop 3
    v_cvt_pk_bf16_f32 v208, v192, v193
    v_cvt_pk_bf16_f32 v209, v194, v195
    v_cvt_pk_bf16_f32 v210, v196, v197
    v_cvt_pk_bf16_f32 v211, v198, v199
    v_cvt_pk_bf16_f32 v212, v200, v201
    v_cvt_pk_bf16_f32 v213, v202, v203
    v_min_u32 v208, -2, v208
    v_min_u32 v210, -2, v210
    v_min_u32 v212, -2, v212
    buffer_store_dwordx2 v[208:209], v34, s[28:31], s64 offen offset:0 sc1
    buffer_store_dwordx2 v[210:211], v34, s[28:31], s64 offen offset:128 sc1
    buffer_store_dwordx2 v[212:213], v35, s[28:31], s64 offen offset:256 sc1
    s_mov_b32 s76, s10
    s_and_b32 s77, s11, 0xffff
    s_mov_b32 s78, 819200
    s_mov_b32 s79, 0x20000
    v_mul_u32_u24 v2, 26, v0
    v_lshrrev_b32 v2, 8, v2
    v_mul_u32_u24 v3, 10, v2
    v_sub_u32 v3, v0, v3
    v_lshlrev_b32 v3, 4, v3
    v_mul_u32_u24 v2, 1280, v2
    v_add_u32 v40, v2, v3
    v_cmp_gt_u32 vcc, 40, v0
    s_lshr_b32 s62, s35, 1
    s_mul_i32 s62, s62, 160
    s_lshl_b32 s40, s33, 1
    s_lshr_b32 s63, s33, 1
    s_add_u32 s65, s40, 1
    s_sub_u32 s65, s65, s63
    s_add_u32 s40, s40, s63
    s_mul_i32 s65, s65, 51200
    s_add_u32 s65, s65, s62
    s_mul_i32 s40, s40, 51200
    s_add_u32 s62, s62, s40
    s_lshr_b32 s63, s33, 1
    s_lshl_b32 s63, s63, 4
    s_and_b32 s40, s33, 1
    s_lshl_b32 s40, s40, 2
    s_add_u32 s63, s63, s40
    s_mul_i32 s63, s63, 160
    s_mov_b64 s[58:59], vcc
    s_waitcnt vmcnt(3)
    s_mov_b32 s60, 32768
    s_mov_b32 s41, 3840
    v_cmp_ne_u32 vcc, s55, v43
    s_cbranch_vccz RC_5
RP_6:
    s_sub_u32 s60, s60, 1
    s_cbranch_scc1 L_end
    buffer_load_dword v43, v42, s[28:31], s41 offen sc1
    s_waitcnt vmcnt(0)
    v_cmp_ne_u32 vcc, s55, v43
    s_cbranch_vccnz RP_6
RC_5:
    v_mov_b32 v2, 153604
    s_mov_b32 s60, 524288
SW_7:
    s_sub_u32 s60, s60, 1
    s_cbranch_scc1 L_end
    ds_read_b32 v3, v2
    s_waitcnt lgkmcnt(0)
    v_readfirstlane_b32 s40, v3
    s_nop 0
    s_cmp_lt_u32 s40, 8
    s_cbranch_scc1 SW_7
    s_mov_b64 exec, s[58:59]
    s_add_u32 m0, s63, 30720
    s_add_u32 s40, s62, 419840
    buffer_load_dwordx4 v40, s[76:79], s40 offen lds
    s_add_u32 m0, s63, 32000
    s_add_u32 s40, s62, 424960
    buffer_load_dwordx4 v40, s[76:79], s40 offen lds
    s_add_u32 m0, s63, 35840
    s_add_u32 s40, s62, 435200
    buffer_load_dwordx4 v40, s[76:79], s40 offen lds
    s_add_u32 m0, s63, 37120
    s_add_u32 s40, s62, 440320
    buffer_load_dwordx4 v40, s[76:79], s40 offen lds
    s_add_u32 m0, s63, 40960
    s_add_u32 s40, s62, 445440
    buffer_load_dwordx4 v40, s[76:79], s40 offen lds
    s_add_u32 m0, s63, 42240
    s_add_u32 s40, s62, 450560
    buffer_load_dwordx4 v40, s[76:79], s40 offen lds
    s_add_u32 m0, s63, 46080
    s_add_u32 s40, s62, 430080
    buffer_load_dwordx4 v40, s[76:79], s40 offen lds
    s_add_u32 m0, s63, 47360
    s_add_u32 s40, s62, 455680
    buffer_load_dwordx4 v40, s[76:79], s40 offen lds
    s_add_u32 m0, s63, 51200
    s_add_u32 s40, s65, 0
    buffer_load_dwordx4 v40, s[76:79], s40 offen lds
    s_add_u32 m0, s63, 52480
    s_add_u32 s40, s65, 5120
    buffer_load_dwordx4 v40, s[76:79], s40 offen lds
    s_add_u32 m0, s63, 56320
    s_add_u32 s40, s65, 10240
    buffer_load_dwordx4 v40, s[76:79], s40 offen lds
    s_add_u32 m0, s63, 57600
    s_add_u32 s40, s65, 15360
    buffer_load_dwordx4 v40, s[76:79], s40 offen lds
    s_add_u32 m0, s63, 61440
    s_add_u32 s40, s65, 25600
    buffer_load_dwordx4 v40, s[76:79], s40 offen lds
    s_add_u32 m0, s63, 62720
    s_add_u32 s40, s65, 30720
    buffer_load_dwordx4 v40, s[76:79], s40 offen lds
    s_mov_b64 exec, -1
    s_mov_b64 s[70:71], s[58:59]
    s_lshl_b32 s44, s35, 16
    s_add_u32 s44, s44, 0
    s_lshl_b32 s40, s33, 6
    v_add_u32 v6, s40, v0
    v_lshlrev_b32 v7, 4, v6
    v_mov_b32 v4, 0x40000000
    v_cmp_gt_u32 vcc, 240, v6
    s_mov_b32 s40, s44
    s_mov_b32 s69, 0xffff
    v_cndmask_b32 v7, v4, v7, vcc
    buffer_load_dwordx4 v[64:67], v7, s[28:31], s40 offen sc1
    s_add_u32 s40, s40, 4096
    buffer_load_dwordx4 v[68:71], v7, s[28:31], s40 offen sc1
    s_add_u32 s40, s40, 4096
    buffer_load_dwordx4 v[72:75], v7, s[28:31], s40 offen sc1
    s_add_u32 s40, s40, 4096
    buffer_load_dwordx4 v[76:79], v7, s[28:31], s40 offen sc1
    s_add_u32 s40, s40, 4096
    buffer_load_dwordx4 v[80:83], v7, s[28:31], s40 offen sc1
    s_add_u32 s40, s40, 4096
    buffer_load_dwordx4 v[84:87], v7, s[28:31], s40 offen sc1
    s_add_u32 s40, s40, 4096
    buffer_load_dwordx4 v[88:91], v7, s[28:31], s40 offen sc1
    s_add_u32 s40, s40, 4096
    buffer_load_dwordx4 v[92:95], v7, s[28:31], s40 offen sc1
    s_add_u32 s40, s40, 4096
    buffer_load_dwordx4 v[96:99], v7, s[28:31], s40 offen sc1
    s_add_u32 s40, s40, 4096
    buffer_load_dwordx4 v[100:103], v7, s[28:31], s40 offen sc1
    s_add_u32 s40, s40, 4096
    buffer_load_dwordx4 v[104:107], v7, s[28:31], s40 offen sc1
    s_add_u32 s40, s40, 4096
    buffer_load_dwordx4 v[108:111], v7, s[28:31], s40 offen sc1
    s_add_u32 s40, s40, 4096
    buffer_load_dwordx4 v[112:115], v7, s[28:31], s40 offen sc1
    s_add_u32 s40, s40, 4096
    buffer_load_dwordx4 v[116:119], v7, s[28:31], s40 offen sc1
    s_add_u32 s40, s40, 4096
    buffer_load_dwordx4 v[120:123], v7, s[28:31], s40 offen sc1
    s_add_u32 s40, s40, 4096
    buffer_load_dwordx4 v[124:127], v7, s[28:31], s40 offen sc1
    s_add_u32 s40, s40, 4096
    v_mov_b32 v128, 0
    v_mov_b32 v129, 0
    v_mov_b32 v130, 0
    v_mov_b32 v131, 0
    v_mov_b32 v132, 0
    v_mov_b32 v133, 0
    v_mov_b32 v134, 0
    v_mov_b32 v135, 0
    v_mul_u32_u24 v4, 205, v6
    v_lshrrev_b32 v4, 12, v4
    v_mul_u32_u24 v5, 20, v4
    v_sub_u32 v5, v6, v5
    v_mul_u32_u24 v5, 96, v5
    v_mul_u32_u24 v8, 43, v4
    v_lshrrev_b32 v8, 8, v8
    v_mul_u32_u24 v9, 6, v8
    v_sub_u32 v9, v4, v9
    v_mul_u32_u24 v8, 1920, v8
    v_lshlrev_b32 v9, 3, v9
    v_add3_u32 v5, v5, v8, v9
    v_add_u32 v4, 154624, v5
    v_mov_b32 v9, 154112
    v_cmp_gt_u32 vcc, 240, v6
    s_nop 1
    v_cndmask_b32 v4, v9, v4, vcc
    v_add_u32 v5, 48, v4
    s_mov_b64 exec, s[70:71]
    s_add_u32 m0, s63, 0
    s_add_u32 s40, s62, 0
    buffer_load_dwordx4 v40, s[76:79], s40 offen lds
    s_add_u32 m0, s63, 1280
    s_add_u32 s40, s62, 5120
    buffer_load_dwordx4 v40, s[76:79], s40 offen lds
    s_add_u32 m0, s63, 5120
    s_add_u32 s40, s62, 10240
    buffer_load_dwordx4 v40, s[76:79], s40 offen lds
    s_add_u32 m0, s63, 6400
    s_add_u32 s40, s62, 15360
    buffer_load_dwordx4 v40, s[76:79], s40 offen lds
    s_add_u32 m0, s63, 10240
    s_add_u32 s40, s62, 25600
    buffer_load_dwordx4 v40, s[76:79], s40 offen lds
    s_add_u32 m0, s63, 11520
    s_add_u32 s40, s62, 30720
    buffer_load_dwordx4 v40, s[76:79], s40 offen lds
    s_add_u32 m0, s63, 15360
    s_add_u32 s40, s62, 35840
    buffer_load_dwordx4 v40, s[76:79], s40 offen lds
    s_add_u32 m0, s63, 16640
    s_add_u32 s40, s62, 40960
    buffer_load_dwordx4 v40, s[76:79], s40 offen lds
    s_mov_b64 exec, -1
    v_mov_b32 v144, 0x00003f80
    v_mov_b32 v145, 0x3f800000
    s_waitcnt vmcnt(23)
    v_max_u32 v138, v64, v66
    v_dot2c_f32_bf16 v128, v64, v144
    v_dot2c_f32_bf16 v129, v64, v145
    v_dot2c_f32_bf16 v130, v65, v144
    v_dot2c_f32_bf16 v131, v65, v145
    v_dot2c_f32_bf16 v132, v66, v144
    v_dot2c_f32_bf16 v133, v66, v145
    v_dot2c_f32_bf16 v134, v67, v144
    v_dot2c_f32_bf16 v135, v67, v145
    s_waitcnt vmcnt(22)
    v_max3_u32 v138, v138, v68, v70
    v_dot2c_f32_bf16 v128, v68, v144
    v_dot2c_f32_bf16 v129, v68, v145
    v_dot2c_f32_bf16 v130, v69, v144
    v_dot2c_f32_bf16 v131, v69, v145
    v_dot2c_f32_bf16 v132, v70, v144
    v_dot2c_f32_bf16 v133, v70, v145
    v_dot2c_f32_bf16 v134, v71, v144
    v_dot2c_f32_bf16 v135, v71, v145
    s_waitcnt vmcnt(21)
    v_max3_u32 v138, v138, v72, v74
    v_dot2c_f32_bf16 v128, v72, v144
    v_dot2c_f32_bf16 v129, v72, v145
    v_dot2c_f32_bf16 v130, v73, v144
    v_dot2c_f32_bf16 v131, v73, v145
    v_dot2c_f32_bf16 v132, v74, v144
    v_dot2c_f32_bf16 v133, v74, v145
    v_dot2c_f32_bf16 v134, v75, v144
    v_dot2c_f32_bf16 v135, v75, v145
    s_waitcnt vmcnt(20)
    v_max3_u32 v138, v138, v76, v78
    v_dot2c_f32_bf16 v128, v76, v144
    v_dot2c_f32_bf16 v129, v76, v145
    v_dot2c_f32_bf16 v130, v77, v144
    v_dot2c_f32_bf16 v131, v77, v145
    v_dot2c_f32_bf16 v132, v78, v144
    v_dot2c_f32_bf16 v133, v78, v145
    v_dot2c_f32_bf16 v134, v79, v144
    v_dot2c_f32_bf16 v135, v79, v145
    s_waitcnt vmcnt(19)
    v_max3_u32 v138, v138, v80, v82
    v_dot2c_f32_bf16 v128, v80, v144
    v_dot2c_f32_bf16 v129, v80, v145
    v_dot2c_f32_bf16 v130, v81, v144
    v_dot2c_f32_bf16 v131, v81, v145
    v_dot2c_f32_bf16 v132, v82, v144
    v_dot2c_f32_bf16 v133, v82, v145
    v_dot2c_f32_bf16 v134, v83, v144
    v_dot2c_f32_bf16 v135, v83, v145
    s_waitcnt vmcnt(18)
    v_max3_u32 v138, v138, v84, v86
    v_dot2c_f32_bf16 v128, v84, v144
    v_dot2c_f32_bf16 v129, v84, v145
    v_dot2c_f32_bf16 v130, v85, v144
    v_dot2c_f32_bf16 v131, v85, v145
    v_dot2c_f32_bf16 v132, v86, v144
    v_dot2c_f32_bf16 v133, v86, v145
    v_dot2c_f32_bf16 v134, v87, v144
    v_dot2c_f32_bf16 v135, v87, v145
    s_waitcnt vmcnt(17)
    v_max3_u32 v138, v138, v88, v90
    v_dot2c_f32_bf16 v128, v88, v144
    v_dot2c_f32_bf16 v129, v88, v145
    v_dot2c_f32_bf16 v130, v89, v144
    v_dot2c_f32_bf16 v131, v89, v145
    v_dot2c_f32_bf16 v132, v90, v144
    v_dot2c_f32_bf16 v133, v90, v145
    v_dot2c_f32_bf16 v134, v91, v144
    v_dot2c_f32_bf16 v135, v91, v145
    s_waitcnt vmcnt(16)
    v_max3_u32 v138, v138, v92, v94
    v_dot2c_f32_bf16 v128, v92, v144
    v_dot2c_f32_bf16 v129, v92, v145
    v_dot2c_f32_bf16 v130, v93, v144
    v_dot2c_f32_bf16 v131, v93, v145
    v_dot2c_f32_bf16 v132, v94, v144
    v_dot2c_f32_bf16 v133, v94, v145
    v_dot2c_f32_bf16 v134, v95, v144
    v_dot2c_f32_bf16 v135, v95, v145
    s_waitcnt vmcnt(15)
    v_max3_u32 v138, v138, v96, v98
    v_dot2c_f32_bf16 v128, v96, v144
    v_dot2c_f32_bf16 v129, v96, v145
    v_dot2c_f32_bf16 v130, v97, v144
    v_dot2c_f32_bf16 v131, v97, v145
    v_dot2c_f32_bf16 v132, v98, v144
    v_dot2c_f32_bf16 v133, v98, v145
    v_dot2c_f32_bf16 v134, v99, v144
    v_dot2c_f32_bf16 v135, v99, v145
    s_waitcnt vmcnt(14)
    v_max3_u32 v138, v138, v100, v102
    v_dot2c_f32_bf16 v128, v100, v144
    v_dot2c_f32_bf16 v129, v100, v145
    v_dot2c_f32_bf16 v130, v101, v144
    v_dot2c_f32_bf16 v131, v101, v145
    v_dot2c_f32_bf16 v132, v102, v144
    v_dot2c_f32_bf16 v133, v102, v145
    v_dot2c_f32_bf16 v134, v103, v144
    v_dot2c_f32_bf16 v135, v103, v145
    s_waitcnt vmcnt(13)
    v_max3_u32 v138, v138, v104, v106
    v_dot2c_f32_bf16 v128, v104, v144
    v_dot2c_f32_bf16 v129, v104, v145
    v_dot2c_f32_bf16 v130, v105, v144
    v_dot2c_f32_bf16 v131, v105, v145
    v_dot2c_f32_bf16 v132, v106, v144
    v_dot2c_f32_bf16 v133, v106, v145
    v_dot2c_f32_bf16 v134, v107, v144
    v_dot2c_f32_bf16 v135, v107, v145
    s_waitcnt vmcnt(12)
    v_max3_u32 v138, v138, v108, v110
    v_dot2c_f32_bf16 v128, v108, v144
    v_dot2c_f32_bf16 v129, v108, v145
    v_dot2c_f32_bf16 v130, v109, v144
    v_dot2c_f32_bf16 v131, v109, v145
    v_dot2c_f32_bf16 v132, v110, v144
    v_dot2c_f32_bf16 v133, v110, v145
    v_dot2c_f32_bf16 v134, v111, v144
    v_dot2c_f32_bf16 v135, v111, v145
    s_waitcnt vmcnt(11)
    v_max3_u32 v138, v138, v112, v114
    v_dot2c_f32_bf16 v128, v112, v144
    v_dot2c_f32_bf16 v129, v112, v145
    v_dot2c_f32_bf16 v130, v113, v144
    v_dot2c_f32_bf16 v131, v113, v145
    v_dot2c_f32_bf16 v132, v114, v144
    v_dot2c_f32_bf16 v133, v114, v145
    v_dot2c_f32_bf16 v134, v115, v144
    v_dot2c_f32_bf16 v135, v115, v145
    s_waitcnt vmcnt(10)
    v_max3_u32 v138, v138, v116, v118
    v_dot2c_f32_bf16 v128, v116, v144
    v_dot2c_f32_bf16 v129, v116, v145
    v_dot2c_f32_bf16 v130, v117, v144
    v_dot2c_f32_bf16 v131, v117, v145
    v_dot2c_f32_bf16 v132, v118, v144
    v_dot2c_f32_bf16 v133, v118, v145
    v_dot2c_f32_bf16 v134, v119, v144
    v_dot2c_f32_bf16 v135, v119, v145
    s_waitcnt vmcnt(9)
    v_max3_u32 v138, v138, v120, v122
    v_dot2c_f32_bf16 v128, v120, v144
    v_dot2c_f32_bf16 v129, v120, v145
    v_dot2c_f32_bf16 v130, v121, v144
    v_dot2c_f32_bf16 v131, v121, v145
    v_dot2c_f32_bf16 v132, v122, v144
    v_dot2c_f32_bf16 v133, v122, v145
    v_dot2c_f32_bf16 v134, v123, v144
    v_dot2c_f32_bf16 v135, v123, v145
    s_waitcnt vmcnt(8)
    v_max3_u32 v138, v138, v124, v126
    v_dot2c_f32_bf16 v128, v124, v144
    v_dot2c_f32_bf16 v129, v124, v145
    v_dot2c_f32_bf16 v130, v125, v144
    v_dot2c_f32_bf16 v131, v125, v145
    v_dot2c_f32_bf16 v132, v126, v144
    v_dot2c_f32_bf16 v133, v126, v145
    v_dot2c_f32_bf16 v134, v127, v144
    v_dot2c_f32_bf16 v135, v127, v145
    v_cmp_eq_u32 vcc, -1, v138
    s_cbranch_vccz L_s1_done
    v_mov_b32 v128, 0
    v_mov_b32 v129, 0
    v_mov_b32 v130, 0
    v_mov_b32 v131, 0
    v_mov_b32 v132, 0
    v_mov_b32 v133, 0
    v_mov_b32 v134, 0
    v_mov_b32 v135, 0
    v_max_u32 v13, v64, v66
    v_cmp_eq_u32 vcc, -1, v13
    s_cbranch_vccnz L_s1a_0
    s_bitset0_b32 s69, 0
    v_dot2c_f32_bf16 v128, v64, v144
    v_dot2c_f32_bf16 v129, v64, v145
    v_dot2c_f32_bf16 v130, v65, v144
    v_dot2c_f32_bf16 v131, v65, v145
    v_dot2c_f32_bf16 v132, v66, v144
    v_dot2c_f32_bf16 v133, v66, v145
    v_dot2c_f32_bf16 v134, v67, v144
    v_dot2c_f32_bf16 v135, v67, v145
L_s1a_0:
    v_max_u32 v13, v68, v70
    v_cmp_eq_u32 vcc, -1, v13
    s_cbranch_vccnz L_s1a_1
    s_bitset0_b32 s69, 1
    v_dot2c_f32_bf16 v128, v68, v144
    v_dot2c_f32_bf16 v129, v68, v145
    v_dot2c_f32_bf16 v130, v69, v144
    v_dot2c_f32_bf16 v131, v69, v145
    v_dot2c_f32_bf16 v132, v70, v144
    v_dot2c_f32_bf16 v133, v70, v145
    v_dot2c_f32_bf16 v134, v71, v144
    v_dot2c_f32_bf16 v135, v71, v145
L_s1a_1:
    v_max_u32 v13, v72, v74
    v_cmp_eq_u32 vcc, -1, v13
    s_cbranch_vccnz L_s1a_2
    s_bitset0_b32 s69, 2
    v_dot2c_f32_bf16 v128, v72, v144
    v_dot2c_f32_bf16 v129, v72, v145
    v_dot2c_f32_bf16 v130, v73, v144
    v_dot2c_f32_bf16 v131, v73, v145
    v_dot2c_f32_bf16 v132, v74, v144
    v_dot2c_f32_bf16 v133, v74, v145
    v_dot2c_f32_bf16 v134, v75, v144
    v_dot2c_f32_bf16 v135, v75, v145
L_s1a_2:
    v_max_u32 v13, v76, v78
    v_cmp_eq_u32 vcc, -1, v13
    s_cbranch_vccnz L_s1a_3
    s_bitset0_b32 s69, 3
    v_dot2c_f32_bf16 v128, v76, v144
    v_dot2c_f32_bf16 v129, v76, v145
    v_dot2c_f32_bf16 v130, v77, v144
    v_dot2c_f32_bf16 v131, v77, v145
    v_dot2c_f32_bf16 v132, v78, v144
    v_dot2c_f32_bf16 v133, v78, v145
    v_dot2c_f32_bf16 v134, v79, v144
    v_dot2c_f32_bf16 v135, v79, v145
L_s1a_3:
    v_max_u32 v13, v80, v82
    v_cmp_eq_u32 vcc, -1, v13
    s_cbranch_vccnz L_s1a_4
    s_bitset0_b32 s69, 4
    v_dot2c_f32_bf16 v128, v80, v144
    v_dot2c_f32_bf16 v129, v80, v145
    v_dot2c_f32_bf16 v130, v81, v144
    v_dot2c_f32_bf16 v131, v81, v145
    v_dot2c_f32_bf16 v132, v82, v144
    v_dot2c_f32_bf16 v133, v82, v145
    v_dot2c_f32_bf16 v134, v83, v144
    v_dot2c_f32_bf16 v135, v83, v145
L_s1a_4:
    v_max_u32 v13, v84, v86
    v_cmp_eq_u32 vcc, -1, v13
    s_cbranch_vccnz L_s1a_5
    s_bitset0_b32 s69, 5
    v_dot2c_f32_bf16 v128, v84, v144
    v_dot2c_f32_bf16 v129, v84, v145
    v_dot2c_f32_bf16 v130, v85, v144
    v_dot2c_f32_bf16 v131, v85, v145
    v_dot2c_f32_bf16 v132, v86, v144
    v_dot2c_f32_bf16 v133, v86, v145
    v_dot2c_f32_bf16 v134, v87, v144
    v_dot2c_f32_bf16 v135, v87, v145
L_s1a_5:
    v_max_u32 v13, v88, v90
    v_cmp_eq_u32 vcc, -1, v13
    s_cbranch_vccnz L_s1a_6
    s_bitset0_b32 s69, 6
    v_dot2c_f32_bf16 v128, v88, v144
    v_dot2c_f32_bf16 v129, v88, v145
    v_dot2c_f32_bf16 v130, v89, v144
    v_dot2c_f32_bf16 v131, v89, v145
    v_dot2c_f32_bf16 v132, v90, v144
    v_dot2c_f32_bf16 v133, v90, v145
    v_dot2c_f32_bf16 v134, v91, v144
    v_dot2c_f32_bf16 v135, v91, v145
L_s1a_6:
    v_max_u32 v13, v92, v94
    v_cmp_eq_u32 vcc, -1, v13
    s_cbranch_vccnz L_s1a_7
    s_bitset0_b32 s69, 7
    v_dot2c_f32_bf16 v128, v92, v144
    v_dot2c_f32_bf16 v129, v92, v145
    v_dot2c_f32_bf16 v130, v93, v144
    v_dot2c_f32_bf16 v131, v93, v145
    v_dot2c_f32_bf16 v132, v94, v144
    v_dot2c_f32_bf16 v133, v94, v145
    v_dot2c_f32_bf16 v134, v95, v144
    v_dot2c_f32_bf16 v135, v95, v145
L_s1a_7:
    v_max_u32 v13, v96, v98
    v_cmp_eq_u32 vcc, -1, v13
    s_cbranch_vccnz L_s1a_8
    s_bitset0_b32 s69, 8
    v_dot2c_f32_bf16 v128, v96, v144
    v_dot2c_f32_bf16 v129, v96, v145
    v_dot2c_f32_bf16 v130, v97, v144
    v_dot2c_f32_bf16 v131, v97, v145
    v_dot2c_f32_bf16 v132, v98, v144
    v_dot2c_f32_bf16 v133, v98, v145
    v_dot2c_f32_bf16 v134, v99, v144
    v_dot2c_f32_bf16 v135, v99, v145
L_s1a_8:
    v_max_u32 v13, v100, v102
    v_cmp_eq_u32 vcc, -1, v13
    s_cbranch_vccnz L_s1a_9
    s_bitset0_b32 s69, 9
    v_dot2c_f32_bf16 v128, v100, v144
    v_dot2c_f32_bf16 v129, v100, v145
    v_dot2c_f32_bf16 v130, v101, v144
    v_dot2c_f32_bf16 v131, v101, v145
    v_dot2c_f32_bf16 v132, v102, v144
    v_dot2c_f32_bf16 v133, v102, v145
    v_dot2c_f32_bf16 v134, v103, v144
    v_dot2c_f32_bf16 v135, v103, v145
L_s1a_9:
    v_max_u32 v13, v104, v106
    v_cmp_eq_u32 vcc, -1, v13
    s_cbranch_vccnz L_s1a_10
    s_bitset0_b32 s69, 10
    v_dot2c_f32_bf16 v128, v104, v144
    v_dot2c_f32_bf16 v129, v104, v145
    v_dot2c_f32_bf16 v130, v105, v144
    v_dot2c_f32_bf16 v131, v105, v145
    v_dot2c_f32_bf16 v132, v106, v144
    v_dot2c_f32_bf16 v133, v106, v145
    v_dot2c_f32_bf16 v134, v107, v144
    v_dot2c_f32_bf16 v135, v107, v145
L_s1a_10:
    v_max_u32 v13, v108, v110
    v_cmp_eq_u32 vcc, -1, v13
    s_cbranch_vccnz L_s1a_11
    s_bitset0_b32 s69, 11
    v_dot2c_f32_bf16 v128, v108, v144
    v_dot2c_f32_bf16 v129, v108, v145
    v_dot2c_f32_bf16 v130, v109, v144
    v_dot2c_f32_bf16 v131, v109, v145
    v_dot2c_f32_bf16 v132, v110, v144
    v_dot2c_f32_bf16 v133, v110, v145
    v_dot2c_f32_bf16 v134, v111, v144
    v_dot2c_f32_bf16 v135, v111, v145
L_s1a_11:
    v_max_u32 v13, v112, v114
    v_cmp_eq_u32 vcc, -1, v13
    s_cbranch_vccnz L_s1a_12
    s_bitset0_b32 s69, 12
    v_dot2c_f32_bf16 v128, v112, v144
    v_dot2c_f32_bf16 v129, v112, v145
    v_dot2c_f32_bf16 v130, v113, v144
    v_dot2c_f32_bf16 v131, v113, v145
    v_dot2c_f32_bf16 v132, v114, v144
    v_dot2c_f32_bf16 v133, v114, v145
    v_dot2c_f32_bf16 v134, v115, v144
    v_dot2c_f32_bf16 v135, v115, v145
L_s1a_12:
    v_max_u32 v13, v116, v118
    v_cmp_eq_u32 vcc, -1, v13
    s_cbranch_vccnz L_s1a_13
    s_bitset0_b32 s69, 13
    v_dot2c_f32_bf16 v128, v116, v144
    v_dot2c_f32_bf16 v129, v116, v145
    v_dot2c_f32_bf16 v130, v117, v144
    v_dot2c_f32_bf16 v131, v117, v145
    v_dot2c_f32_bf16 v132, v118, v144
    v_dot2c_f32_bf16 v133, v118, v145
    v_dot2c_f32_bf16 v134, v119, v144
    v_dot2c_f32_bf16 v135, v119, v145
L_s1a_13:
    v_max_u32 v13, v120, v122
    v_cmp_eq_u32 vcc, -1, v13
    s_cbranch_vccnz L_s1a_14
    s_bitset0_b32 s69, 14
    v_dot2c_f32_bf16 v128, v120, v144
    v_dot2c_f32_bf16 v129, v120, v145
    v_dot2c_f32_bf16 v130, v121, v144
    v_dot2c_f32_bf16 v131, v121, v145
    v_dot2c_f32_bf16 v132, v122, v144
    v_dot2c_f32_bf16 v133, v122, v145
    v_dot2c_f32_bf16 v134, v123, v144
    v_dot2c_f32_bf16 v135, v123, v145
L_s1a_14:
    v_max_u32 v13, v124, v126
    v_cmp_eq_u32 vcc, -1, v13
    s_cbranch_vccnz L_s1a_15
    s_bitset0_b32 s69, 15
    v_dot2c_f32_bf16 v128, v124, v144
    v_dot2c_f32_bf16 v129, v124, v145
    v_dot2c_f32_bf16 v130, v125, v144
    v_dot2c_f32_bf16 v131, v125, v145
    v_dot2c_f32_bf16 v132, v126, v144
    v_dot2c_f32_bf16 v133, v126, v145
    v_dot2c_f32_bf16 v134, v127, v144
    v_dot2c_f32_bf16 v135, v127, v145
L_s1a_15:
    s_mov_b32 s60, 32768
L_s1_loop:
    s_cmp_eq_u32 s69, 0
    s_cbranch_scc1 L_s1_done
    s_sub_u32 s60, s60, 1
    s_cbranch_scc1 L_end
    s_bitcmp0_b32 s69, 0
    s_cbranch_scc1 L_s1l_0
    s_add_u32 s40, s44, 0
    buffer_load_dwordx4 v[64:67], v7, s[28:31], s40 offen sc1
L_s1l_0:
    s_bitcmp0_b32 s69, 1
    s_cbranch_scc1 L_s1l_1
    s_add_u32 s40, s44, 4096
    buffer_load_dwordx4 v[68:71], v7, s[28:31], s40 offen sc1
L_s1l_1:
    s_bitcmp0_b32 s69, 2
    s_cbranch_scc1 L_s1l_2
    s_add_u32 s40, s44, 8192
    buffer_load_dwordx4 v[72:75], v7, s[28:31], s40 offen sc1
L_s1l_2:
    s_bitcmp0_b32 s69, 3
    s_cbranch_scc1 L_s1l_3
    s_add_u32 s40, s44, 12288
    buffer_load_dwordx4 v[76:79], v7, s[28:31], s40 offen sc1
L_s1l_3:
    s_bitcmp0_b32 s69, 4
    s_cbranch_scc1 L_s1l_4
    s_add_u32 s40, s44, 16384
    buffer_load_dwordx4 v[80:83], v7, s[28:31], s40 offen sc1
L_s1l_4:
    s_bitcmp0_b32 s69, 5
    s_cbranch_scc1 L_s1l_5
    s_add_u32 s40, s44, 20480
    buffer_load_dwordx4 v[84:87], v7, s[28:31], s40 offen sc1
L_s1l_5:
    s_bitcmp0_b32 s69, 6
    s_cbranch_scc1 L_s1l_6
    s_add_u32 s40, s44, 24576
    buffer_load_dwordx4 v[88:91], v7, s[28:31], s40 offen sc1
L_s1l_6:
    s_bitcmp0_b32 s69, 7
    s_cbranch_scc1 L_s1l_7
    s_add_u32 s40, s44, 28672
    buffer_load_dwordx4 v[92:95], v7, s[28:31], s40 offen sc1
L_s1l_7:
    s_bitcmp0_b32 s69, 8
    s_cbranch_scc1 L_s1l_8
    s_add_u32 s40, s44, 32768
    buffer_load_dwordx4 v[96:99], v7, s[28:31], s40 offen sc1
L_s1l_8:
    s_bitcmp0_b32 s69, 9
    s_cbranch_scc1 L_s1l_9
    s_add_u32 s40, s44, 36864
    buffer_load_dwordx4 v[100:103], v7, s[28:31], s40 offen sc1
L_s1l_9:
    s_bitcmp0_b32 s69, 10
    s_cbranch_scc1 L_s1l_10
    s_add_u32 s40, s44, 40960
    buffer_load_dwordx4 v[104:107], v7, s[28:31], s40 offen sc1
L_s1l_10:
    s_bitcmp0_b32 s69, 11
    s_cbranch_scc1 L_s1l_11
    s_add_u32 s40, s44, 45056
    buffer_load_dwordx4 v[108:111], v7, s[28:31], s40 offen sc1
L_s1l_11:
    s_bitcmp0_b32 s69, 12
    s_cbranch_scc1 L_s1l_12
    s_add_u32 s40, s44, 49152
    buffer_load_dwordx4 v[112:115], v7, s[28:31], s40 offen sc1
L_s1l_12:
    s_bitcmp0_b32 s69, 13
    s_cbranch_scc1 L_s1l_13
    s_add_u32 s40, s44, 53248
    buffer_load_dwordx4 v[116:119], v7, s[28:31], s40 offen sc1
L_s1l_13:
    s_bitcmp0_b32 s69, 14
    s_cbranch_scc1 L_s1l_14
    s_add_u32 s40, s44, 57344
    buffer_load_dwordx4 v[120:123], v7, s[28:31], s40 offen sc1
L_s1l_14:
    s_bitcmp0_b32 s69, 15
    s_cbranch_scc1 L_s1l_15
    s_add_u32 s40, s44, 61440
    buffer_load_dwordx4 v[124:127], v7, s[28:31], s40 offen sc1
L_s1l_15:
    s_waitcnt vmcnt(0)
    s_bitcmp0_b32 s69, 0
    s_cbranch_scc1 L_s1b_0
    v_max_u32 v13, v64, v66
    v_cmp_eq_u32 vcc, -1, v13
    s_cbranch_vccnz L_s1b_0
    s_bitset0_b32 s69, 0
    v_dot2c_f32_bf16 v128, v64, v144
    v_dot2c_f32_bf16 v129, v64, v145
    v_dot2c_f32_bf16 v130, v65, v144
    v_dot2c_f32_bf16 v131, v65, v145
    v_dot2c_f32_bf16 v132, v66, v144
    v_dot2c_f32_bf16 v133, v66, v145
    v_dot2c_f32_bf16 v134, v67, v144
    v_dot2c_f32_bf16 v135, v67, v145
L_s1b_0:
    s_bitcmp0_b32 s69, 1
    s_cbranch_scc1 L_s1b_1
    v_max_u32 v13, v68, v70
    v_cmp_eq_u32 vcc, -1, v13
    s_cbranch_vccnz L_s1b_1
    s_bitset0_b32 s69, 1
    v_dot2c_f32_bf16 v128, v68, v144
    v_dot2c_f32_bf16 v129, v68, v145
    v_dot2c_f32_bf16 v130, v69, v144
    v_dot2c_f32_bf16 v131, v69, v145
    v_dot2c_f32_bf16 v132, v70, v144
    v_dot2c_f32_bf16 v133, v70, v145
    v_dot2c_f32_bf16 v134, v71, v144
    v_dot2c_f32_bf16 v135, v71, v145
L_s1b_1:
    s_bitcmp0_b32 s69, 2
    s_cbranch_scc1 L_s1b_2
    v_max_u32 v13, v72, v74
    v_cmp_eq_u32 vcc, -1, v13
    s_cbranch_vccnz L_s1b_2
    s_bitset0_b32 s69, 2
    v_dot2c_f32_bf16 v128, v72, v144
    v_dot2c_f32_bf16 v129, v72, v145
    v_dot2c_f32_bf16 v130, v73, v144
    v_dot2c_f32_bf16 v131, v73, v145
    v_dot2c_f32_bf16 v132, v74, v144
    v_dot2c_f32_bf16 v133, v74, v145
    v_dot2c_f32_bf16 v134, v75, v144
    v_dot2c_f32_bf16 v135, v75, v145
L_s1b_2:
    s_bitcmp0_b32 s69, 3
    s_cbranch_scc1 L_s1b_3
    v_max_u32 v13, v76, v78
    v_cmp_eq_u32 vcc, -1, v13
    s_cbranch_vccnz L_s1b_3
    s_bitset0_b32 s69, 3
    v_dot2c_f32_bf16 v128, v76, v144
    v_dot2c_f32_bf16 v129, v76, v145
    v_dot2c_f32_bf16 v130, v77, v144
    v_dot2c_f32_bf16 v131, v77, v145
    v_dot2c_f32_bf16 v132, v78, v144
    v_dot2c_f32_bf16 v133, v78, v145
    v_dot2c_f32_bf16 v134, v79, v144
    v_dot2c_f32_bf16 v135, v79, v145
L_s1b_3:
    s_bitcmp0_b32 s69, 4
    s_cbranch_scc1 L_s1b_4
    v_max_u32 v13, v80, v82
    v_cmp_eq_u32 vcc, -1, v13
    s_cbranch_vccnz L_s1b_4
    s_bitset0_b32 s69, 4
    v_dot2c_f32_bf16 v128, v80, v144
    v_dot2c_f32_bf16 v129, v80, v145
    v_dot2c_f32_bf16 v130, v81, v144
    v_dot2c_f32_bf16 v131, v81, v145
    v_dot2c_f32_bf16 v132, v82, v144
    v_dot2c_f32_bf16 v133, v82, v145
    v_dot2c_f32_bf16 v134, v83, v144
    v_dot2c_f32_bf16 v135, v83, v145
L_s1b_4:
    s_bitcmp0_b32 s69, 5
    s_cbranch_scc1 L_s1b_5
    v_max_u32 v13, v84, v86
    v_cmp_eq_u32 vcc, -1, v13
    s_cbranch_vccnz L_s1b_5
    s_bitset0_b32 s69, 5
    v_dot2c_f32_bf16 v128, v84, v144
    v_dot2c_f32_bf16 v129, v84, v145
    v_dot2c_f32_bf16 v130, v85, v144
    v_dot2c_f32_bf16 v131, v85, v145
    v_dot2c_f32_bf16 v132, v86, v144
    v_dot2c_f32_bf16 v133, v86, v145
    v_dot2c_f32_bf16 v134, v87, v144
    v_dot2c_f32_bf16 v135, v87, v145
L_s1b_5:
    s_bitcmp0_b32 s69, 6
    s_cbranch_scc1 L_s1b_6
    v_max_u32 v13, v88, v90
    v_cmp_eq_u32 vcc, -1, v13
    s_cbranch_vccnz L_s1b_6
    s_bitset0_b32 s69, 6
    v_dot2c_f32_bf16 v128, v88, v144
    v_dot2c_f32_bf16 v129, v88, v145
    v_dot2c_f32_bf16 v130, v89, v144
    v_dot2c_f32_bf16 v131, v89, v145
    v_dot2c_f32_bf16 v132, v90, v144
    v_dot2c_f32_bf16 v133, v90, v145
    v_dot2c_f32_bf16 v134, v91, v144
    v_dot2c_f32_bf16 v135, v91, v145
L_s1b_6:
    s_bitcmp0_b32 s69, 7
    s_cbranch_scc1 L_s1b_7
    v_max_u32 v13, v92, v94
    v_cmp_eq_u32 vcc, -1, v13
    s_cbranch_vccnz L_s1b_7
    s_bitset0_b32 s69, 7
    v_dot2c_f32_bf16 v128, v92, v144
    v_dot2c_f32_bf16 v129, v92, v145
    v_dot2c_f32_bf16 v130, v93, v144
    v_dot2c_f32_bf16 v131, v93, v145
    v_dot2c_f32_bf16 v132, v94, v144
    v_dot2c_f32_bf16 v133, v94, v145
    v_dot2c_f32_bf16 v134, v95, v144
    v_dot2c_f32_bf16 v135, v95, v145
L_s1b_7:
    s_bitcmp0_b32 s69, 8
    s_cbranch_scc1 L_s1b_8
    v_max_u32 v13, v96, v98
    v_cmp_eq_u32 vcc, -1, v13
    s_cbranch_vccnz L_s1b_8
    s_bitset0_b32 s69, 8
    v_dot2c_f32_bf16 v128, v96, v144
    v_dot2c_f32_bf16 v129, v96, v145
    v_dot2c_f32_bf16 v130, v97, v144
    v_dot2c_f32_bf16 v131, v97, v145
    v_dot2c_f32_bf16 v132, v98, v144
    v_dot2c_f32_bf16 v133, v98, v145
    v_dot2c_f32_bf16 v134, v99, v144
    v_dot2c_f32_bf16 v135, v99, v145
L_s1b_8:
    s_bitcmp0_b32 s69, 9
    s_cbranch_scc1 L_s1b_9
    v_max_u32 v13, v100, v102
    v_cmp_eq_u32 vcc, -1, v13
    s_cbranch_vccnz L_s1b_9
    s_bitset0_b32 s69, 9
    v_dot2c_f32_bf16 v128, v100, v144
    v_dot2c_f32_bf16 v129, v100, v145
    v_dot2c_f32_bf16 v130, v101, v144
    v_dot2c_f32_bf16 v131, v101, v145
    v_dot2c_f32_bf16 v132, v102, v144
    v_dot2c_f32_bf16 v133, v102, v145
    v_dot2c_f32_bf16 v134, v103, v144
    v_dot2c_f32_bf16 v135, v103, v145
L_s1b_9:
    s_bitcmp0_b32 s69, 10
    s_cbranch_scc1 L_s1b_10
    v_max_u32 v13, v104, v106
    v_cmp_eq_u32 vcc, -1, v13
    s_cbranch_vccnz L_s1b_10
    s_bitset0_b32 s69, 10
    v_dot2c_f32_bf16 v128, v104, v144
    v_dot2c_f32_bf16 v129, v104, v145
    v_dot2c_f32_bf16 v130, v105, v144
    v_dot2c_f32_bf16 v131, v105, v145
    v_dot2c_f32_bf16 v132, v106, v144
    v_dot2c_f32_bf16 v133, v106, v145
    v_dot2c_f32_bf16 v134, v107, v144
    v_dot2c_f32_bf16 v135, v107, v145
L_s1b_10:
    s_bitcmp0_b32 s69, 11
    s_cbranch_scc1 L_s1b_11
    v_max_u32 v13, v108, v110
    v_cmp_eq_u32 vcc, -1, v13
    s_cbranch_vccnz L_s1b_11
    s_bitset0_b32 s69, 11
    v_dot2c_f32_bf16 v128, v108, v144
    v_dot2c_f32_bf16 v129, v108, v145
    v_dot2c_f32_bf16 v130, v109, v144
    v_dot2c_f32_bf16 v131, v109, v145
    v_dot2c_f32_bf16 v132, v110, v144
    v_dot2c_f32_bf16 v133, v110, v145
    v_dot2c_f32_bf16 v134, v111, v144
    v_dot2c_f32_bf16 v135, v111, v145
L_s1b_11:
    s_bitcmp0_b32 s69, 12
    s_cbranch_scc1 L_s1b_12
    v_max_u32 v13, v112, v114
    v_cmp_eq_u32 vcc, -1, v13
    s_cbranch_vccnz L_s1b_12
    s_bitset0_b32 s69, 12
    v_dot2c_f32_bf16 v128, v112, v144
    v_dot2c_f32_bf16 v129, v112, v145
    v_dot2c_f32_bf16 v130, v113, v144
    v_dot2c_f32_bf16 v131, v113, v145
    v_dot2c_f32_bf16 v132, v114, v144
    v_dot2c_f32_bf16 v133, v114, v145
    v_dot2c_f32_bf16 v134, v115, v144
    v_dot2c_f32_bf16 v135, v115, v145
L_s1b_12:
    s_bitcmp0_b32 s69, 13
    s_cbranch_scc1 L_s1b_13
    v_max_u32 v13, v116, v118
    v_cmp_eq_u32 vcc, -1, v13
    s_cbranch_vccnz L_s1b_13
    s_bitset0_b32 s69, 13
    v_dot2c_f32_bf16 v128, v116, v144
    v_dot2c_f32_bf16 v129, v116, v145
    v_dot2c_f32_bf16 v130, v117, v144
    v_dot2c_f32_bf16 v131, v117, v145
    v_dot2c_f32_bf16 v132, v118, v144
    v_dot2c_f32_bf16 v133, v118, v145
    v_dot2c_f32_bf16 v134, v119, v144
    v_dot2c_f32_bf16 v135, v119, v145
L_s1b_13:
    s_bitcmp0_b32 s69, 14
    s_cbranch_scc1 L_s1b_14
    v_max_u32 v13, v120, v122
    v_cmp_eq_u32 vcc, -1, v13
    s_cbranch_vccnz L_s1b_14
    s_bitset0_b32 s69, 14
    v_dot2c_f32_bf16 v128, v120, v144
    v_dot2c_f32_bf16 v129, v120, v145
    v_dot2c_f32_bf16 v130, v121, v144
    v_dot2c_f32_bf16 v131, v121, v145
    v_dot2c_f32_bf16 v132, v122, v144
    v_dot2c_f32_bf16 v133, v122, v145
    v_dot2c_f32_bf16 v134, v123, v144
    v_dot2c_f32_bf16 v135, v123, v145
L_s1b_14:
    s_bitcmp0_b32 s69, 15
    s_cbranch_scc1 L_s1b_15
    v_max_u32 v13, v124, v126
    v_cmp_eq_u32 vcc, -1, v13
    s_cbranch_vccnz L_s1b_15
    s_bitset0_b32 s69, 15
    v_dot2c_f32_bf16 v128, v124, v144
    v_dot2c_f32_bf16 v129, v124, v145
    v_dot2c_f32_bf16 v130, v125, v144
    v_dot2c_f32_bf16 v131, v125, v145
    v_dot2c_f32_bf16 v132, v126, v144
    v_dot2c_f32_bf16 v133, v126, v145
    v_dot2c_f32_bf16 v134, v127, v144
    v_dot2c_f32_bf16 v135, v127, v145
L_s1b_15:
    s_branch L_s1_loop
L_s1_done:
    s_nop 7
    v_cvt_pk_bf16_f32 v140, v128, v129
    v_cvt_pk_bf16_f32 v141, v130, v131
    v_cvt_pk_bf16_f32 v142, v132, v133
    v_cvt_pk_bf16_f32 v143, v134, v135
    ds_write_b64 v4, v[140:141]
    ds_write_b64 v5, v[142:143]
    v_mov_b32 v2, 153608
    v_mov_b32 v3, 1
    s_mov_b64 exec, 1
    ds_add_u32 v2, v3
    s_mov_b64 exec, -1
    s_mov_b64 exec, s[70:71]
    s_add_u32 m0, s63, 20480
    s_add_u32 s40, s62, 20480
    buffer_load_dwordx4 v40, s[76:79], s40 offen lds
    s_add_u32 m0, s63, 21760
    s_add_u32 s40, s62, 46080
    buffer_load_dwordx4 v40, s[76:79], s40 offen lds
    s_add_u32 m0, s63, 25600
    s_add_u32 s40, s62, 409600
    buffer_load_dwordx4 v40, s[76:79], s40 offen lds
    s_add_u32 m0, s63, 26880
    s_add_u32 s40, s62, 414720
    buffer_load_dwordx4 v40, s[76:79], s40 offen lds
    s_add_u32 m0, s63, 66560
    s_add_u32 s40, s65, 35840
    buffer_load_dwordx4 v40, s[76:79], s40 offen lds
    s_add_u32 m0, s63, 67840
    s_add_u32 s40, s65, 40960
    buffer_load_dwordx4 v40, s[76:79], s40 offen lds
    s_add_u32 m0, s63, 71680
    s_add_u32 s40, s65, 20480
    buffer_load_dwordx4 v40, s[76:79], s40 offen lds
    s_add_u32 m0, s63, 72960
    s_add_u32 s40, s65, 46080
    buffer_load_dwordx4 v40, s[76:79], s40 offen lds
    s_add_u32 m0, s63, 76800
    s_add_u32 s40, s65, 409600
    buffer_load_dwordx4 v40, s[76:79], s40 offen lds
    s_add_u32 m0, s63, 78080
    s_add_u32 s40, s65, 414720
    buffer_load_dwordx4 v40, s[76:79], s40 offen lds
    s_add_u32 m0, s63, 81920
    s_add_u32 s40, s65, 419840
    buffer_load_dwordx4 v40, s[76:79], s40 offen lds
    s_add_u32 m0, s63, 83200
    s_add_u32 s40, s65, 424960
    buffer_load_dwordx4 v40, s[76:79], s40 offen lds
    s_add_u32 m0, s63, 87040
    s_add_u32 s40, s65, 435200
    buffer_load_dwordx4 v40, s[76:79], s40 offen lds
    s_add_u32 m0, s63, 88320
    s_add_u32 s40, s65, 440320
    buffer_load_dwordx4 v40, s[76:79], s40 offen lds
    s_add_u32 m0, s63, 92160
    s_add_u32 s40, s65, 445440
    buffer_load_dwordx4 v40, s[76:79], s40 offen lds
    s_add_u32 m0, s63, 93440
    s_add_u32 s40, s65, 450560
    buffer_load_dwordx4 v40, s[76:79], s40 offen lds
    s_add_u32 m0, s63, 158464
    s_add_u32 s40, s65, 430080
    buffer_load_dwordx4 v40, s[76:79], s40 offen lds
    s_add_u32 m0, s63, 159744
    s_add_u32 s40, s65, 455680
    buffer_load_dwordx4 v40, s[76:79], s40 offen lds
    s_mov_b64 exec, -1
    v_lshrrev_b32 v2, 4, v0
    v_bfe_u32 v3, v0, 2, 2
    v_and_b32 v4, 3, v0
    v_lshrrev_b32 v5, 1, v2
    v_lshlrev_b32 v5, 4, v5
    v_and_b32 v6, 1, v2
    v_lshlrev_b32 v6, 2, v6
    v_add3_u32 v5, v5, v6, v3
    v_mul_u32_u24 v5, 160, v5
    v_lshlrev_b32 v4, 3, v4
    v_add_u32 v10, v5, v4
    v_add_u32 v11, 0x10000, v10
    v_add_u32 v12, 0x20000, v10
    s_and_b32 s40, s35, 1
    s_lshl_b32 s40, s40, 2
    s_add_u32 s40, s40, s33
    s_lshl_b32 s41, s34, 3
    s_add_u32 s46, s40, s41
    s_mul_i32 s44, s46, 20480
    s_add_u32 s44, s44, 1048576
    v_and_b32 v2, 15, v0
    v_lshrrev_b32 v3, 2, v2
    v_mul_u32_u24 v3, 5120, v3
    v_and_b32 v4, 3, v2
    v_lshlrev_b32 v4, 8, v4
    v_add3_u32 v2, v3, v4, 0
    v_add_u32 v2, 4096, v2
    v_lshlrev_b32 v7, 4, v0
    s_waitcnt vmcnt(0)
    v_mov_b32 v8, 153624
    v_mov_b32 v9, 1
    s_mov_b64 exec, 1
    ds_add_u32 v8, v9
    s_mov_b64 exec, -1
    v_mov_b32 v8, 153624
    s_mov_b32 s60, 524288
SW_8:
    s_sub_u32 s60, s60, 1
    s_cbranch_scc1 L_end
    ds_read_b32 v9, v8
    s_waitcnt lgkmcnt(0)
    v_readfirstlane_b32 s40, v9
    s_nop 0
    s_cmp_lt_u32 s40, 4
    s_cbranch_scc1 SW_8
    buffer_load_dword v3, v2, s[28:31], s44 offen sc1
    ds_read_b64_tr_b16 v[176:177], v10 offset:0
    ds_read_b64_tr_b16 v[178:179], v10 offset:1280
    ds_read_b64_tr_b16 v[180:181], v10 offset:32
    ds_read_b64_tr_b16 v[182:183], v10 offset:1312
    ds_read_b64_tr_b16 v[184:185], v10 offset:64
    ds_read_b64_tr_b16 v[186:187], v10 offset:1344
    ds_read_b64_tr_b16 v[188:189], v10 offset:96
    ds_read_b64_tr_b16 v[190:191], v10 offset:1376
    ds_read_b64_tr_b16 v[192:193], v10 offset:128
    ds_read_b64_tr_b16 v[194:195], v10 offset:1408
    ds_read_b64_tr_b16 v[196:197], v10 offset:5120
    ds_read_b64_tr_b16 v[198:199], v10 offset:6400
    ds_read_b64_tr_b16 v[200:201], v10 offset:5152
    ds_read_b64_tr_b16 v[202:203], v10 offset:6432
    ds_read_b64_tr_b16 v[204:205], v10 offset:5184
    ds_read_b64_tr_b16 v[206:207], v10 offset:6464
    ds_read_b64_tr_b16 v[208:209], v10 offset:5216
    ds_read_b64_tr_b16 v[210:211], v10 offset:6496
    ds_read_b64_tr_b16 v[212:213], v10 offset:5248
    ds_read_b64_tr_b16 v[214:215], v10 offset:6528
    ds_read_b64_tr_b16 v[216:217], v10 offset:10240
    ds_read_b64_tr_b16 v[218:219], v10 offset:11520
    ds_read_b64_tr_b16 v[220:221], v10 offset:10272
    ds_read_b64_tr_b16 v[222:223], v10 offset:11552
    ds_read_b64_tr_b16 v[224:225], v10 offset:10304
    ds_read_b64_tr_b16 v[226:227], v10 offset:11584
    ds_read_b64_tr_b16 v[228:229], v10 offset:10336
    ds_read_b64_tr_b16 v[230:231], v10 offset:11616
    ds_read_b64_tr_b16 v[232:233], v10 offset:10368
    ds_read_b64_tr_b16 v[234:235], v10 offset:11648
    ds_read_b64_tr_b16 v[236:237], v10 offset:15360
    ds_read_b64_tr_b16 v[238:239], v10 offset:16640
    ds_read_b64_tr_b16 v[240:241], v10 offset:15392
    ds_read_b64_tr_b16 v[242:243], v10 offset:16672
    ds_read_b64_tr_b16 v[244:245], v10 offset:15424
    ds_read_b64_tr_b16 v[246:247], v10 offset:16704
    ds_read_b64_tr_b16 v[248:249], v10 offset:15456
    ds_read_b64_tr_b16 v[250:251], v10 offset:16736
    ds_read_b64_tr_b16 v[252:253], v10 offset:15488
    ds_read_b64_tr_b16 v[254:255], v10 offset:16768
    ds_read_b64_tr_b16 v[60:61], v10 offset:20480
    ds_read_b64_tr_b16 v[62:63], v10 offset:21760
    ds_read_b64_tr_b16 v[64:65], v10 offset:20512
    ds_read_b64_tr_b16 v[66:67], v10 offset:21792
    ds_read_b64_tr_b16 v[68:69], v10 offset:20544
    ds_read_b64_tr_b16 v[70:71], v10 offset:21824
    ds_read_b64_tr_b16 v[72:73], v10 offset:20576
    ds_read_b64_tr_b16 v[74:75], v10 offset:21856
    ds_read_b64_tr_b16 v[76:77], v10 offset:20608
    ds_read_b64_tr_b16 v[78:79], v10 offset:21888
    ds_read_b64_tr_b16 v[16:17], v10 offset:25600
    ds_read_b64_tr_b16 v[18:19], v10 offset:26880
    ds_read_b64_tr_b16 v[20:21], v10 offset:25632
    ds_read_b64_tr_b16 v[22:23], v10 offset:26912
    ds_read_b64_tr_b16 v[24:25], v10 offset:25664
    ds_read_b64_tr_b16 v[26:27], v10 offset:26944
    ds_read_b64_tr_b16 v[28:29], v10 offset:25696
    ds_read_b64_tr_b16 v[30:31], v10 offset:26976
    ds_read_b64_tr_b16 v[32:33], v10 offset:25728
    ds_read_b64_tr_b16 v[34:35], v10 offset:27008
    s_mov_b32 s60, 32768
    s_mov_b32 s68, 0
    s_mov_b32 s42, 0x00ff00ff
    s_mov_b32 s43, 0x00ff00ff
L_s2f_chk:
    s_waitcnt vmcnt(0)
    v_cmp_eq_u32 vcc, -1, v3
    s_and_b64 vcc, vcc, s[42:43]
    s_cbranch_vccz L_s2f_go
    s_sub_u32 s60, s60, 1
    s_cbranch_scc1 L_end
    buffer_load_dword v3, v2, s[28:31], s44 offen sc1
    s_branch L_s2f_chk
L_s2f_go:
    s_mov_b32 s40, s44
    buffer_load_dwordx4 v[96:99], v7, s[28:31], s40 offen offset:0 sc1
    buffer_load_dwordx4 v[100:103], v7, s[28:31], s40 offen offset:1024 sc1
    buffer_load_dwordx4 v[104:107], v7, s[28:31], s40 offen offset:2048 sc1
    buffer_load_dwordx4 v[108:111], v7, s[28:31], s40 offen offset:3072 sc1
    s_add_u32 s40, s40, 4096
    buffer_load_dwordx4 v[112:115], v7, s[28:31], s40 offen offset:0 sc1
    buffer_load_dwordx4 v[116:119], v7, s[28:31], s40 offen offset:1024 sc1
    buffer_load_dwordx4 v[120:123], v7, s[28:31], s40 offen offset:2048 sc1
    buffer_load_dwordx4 v[124:127], v7, s[28:31], s40 offen offset:3072 sc1
    s_add_u32 s40, s40, 4096
    buffer_load_dwordx4 v[128:131], v7, s[28:31], s40 offen offset:0 sc1
    buffer_load_dwordx4 v[132:135], v7, s[28:31], s40 offen offset:1024 sc1
    s_mov_b32 s42, 0xff00ff00
    s_mov_b32 s43, 0xff00ff00
    v_cmp_eq_u32 vcc, -1, v3
    s_and_b64 vcc, vcc, s[42:43]
    s_cbranch_vccz L_s2_sl
    buffer_load_dword v3, v2, s[28:31], s44 offen sc1
    s_waitcnt vmcnt(0)
    v_cmp_eq_u32 vcc, -1, v3
    s_and_b64 vcc, vcc, s[42:43]
    s_cbranch_vccz L_s2_sl
    buffer_load_dword v3, v2, s[28:31], s44 offen sc1
    s_branch L_s2_p
L_s2_sl:
    s_mov_b32 s68, 2
    s_add_u32 s40, s44, 8192
    buffer_load_dwordx4 v[136:139], v7, s[28:31], s40 offen offset:2048 sc1
    buffer_load_dwordx4 v[140:143], v7, s[28:31], s40 offen offset:3072 sc1
    s_add_u32 s40, s40, 4096
    buffer_load_dwordx4 v[144:147], v7, s[28:31], s40 offen offset:0 sc1
    buffer_load_dwordx4 v[148:151], v7, s[28:31], s40 offen offset:1024 sc1
    buffer_load_dwordx4 v[152:155], v7, s[28:31], s40 offen offset:2048 sc1
    buffer_load_dwordx4 v[156:159], v7, s[28:31], s40 offen offset:3072 sc1
    s_add_u32 s40, s40, 4096
    buffer_load_dwordx4 v[160:163], v7, s[28:31], s40 offen offset:0 sc1
    buffer_load_dwordx4 v[164:167], v7, s[28:31], s40 offen offset:1024 sc1
    buffer_load_dwordx4 v[168:171], v7, s[28:31], s40 offen offset:2048 sc1
    buffer_load_dwordx4 v[172:175], v7, s[28:31], s40 offen offset:3072 sc1
    s_add_u32 s40, s40, 4096
L_s2_p:
    s_mov_b32 s60, 32768
    s_waitcnt vmcnt(19) lgkmcnt(0)
L_chk_0:
    v_max_u32 v13, v96, v98
    v_cmp_eq_u32 vcc, -1, v13
    s_cbranch_vccnz L_rt_0
    v_mfma_f32_16x16x32_bf16 v[40:43], v[176:179], v[96:99], 0
    ds_read_b64_tr_b16 v[176:177], v10 offset:30720
    ds_read_b64_tr_b16 v[178:179], v10 offset:32000
    v_mfma_f32_16x16x32_bf16 v[44:47], v[180:183], v[96:99], 0
    ds_read_b64_tr_b16 v[180:181], v10 offset:30752
    ds_read_b64_tr_b16 v[182:183], v10 offset:32032
    v_mfma_f32_16x16x32_bf16 v[48:51], v[184:187], v[96:99], 0
    ds_read_b64_tr_b16 v[184:185], v10 offset:30784
    ds_read_b64_tr_b16 v[186:187], v10 offset:32064
    v_mfma_f32_16x16x32_bf16 v[52:55], v[188:191], v[96:99], 0
    ds_read_b64_tr_b16 v[188:189], v10 offset:30816
    ds_read_b64_tr_b16 v[190:191], v10 offset:32096
    v_mfma_f32_16x16x32_bf16 v[56:59], v[192:195], v[96:99], 0
    ds_read_b64_tr_b16 v[192:193], v10 offset:30848
    ds_read_b64_tr_b16 v[194:195], v10 offset:32128
    s_waitcnt vmcnt(18) lgkmcnt(10)
L_chk_1:
    v_max_u32 v13, v100, v102
    v_cmp_eq_u32 vcc, -1, v13
    s_cbranch_vccnz L_rt_1
    v_mfma_f32_16x16x32_bf16 v[40:43], v[196:199], v[100:103], v[40:43]
    ds_read_b64_tr_b16 v[196:197], v10 offset:35840
    ds_read_b64_tr_b16 v[198:199], v10 offset:37120
    v_mfma_f32_16x16x32_bf16 v[44:47], v[200:203], v[100:103], v[44:47]
    ds_read_b64_tr_b16 v[200:201], v10 offset:35872
    ds_read_b64_tr_b16 v[202:203], v10 offset:37152
    v_mfma_f32_16x16x32_bf16 v[48:51], v[204:207], v[100:103], v[48:51]
    ds_read_b64_tr_b16 v[204:205], v10 offset:35904
    ds_read_b64_tr_b16 v[206:207], v10 offset:37184
    v_mfma_f32_16x16x32_bf16 v[52:55], v[208:211], v[100:103], v[52:55]
    ds_read_b64_tr_b16 v[208:209], v10 offset:35936
    ds_read_b64_tr_b16 v[210:211], v10 offset:37216
    v_mfma_f32_16x16x32_bf16 v[56:59], v[212:215], v[100:103], v[56:59]
    ds_read_b64_tr_b16 v[212:213], v10 offset:35968
    ds_read_b64_tr_b16 v[214:215], v10 offset:37248
    s_waitcnt vmcnt(17) lgkmcnt(10)
L_chk_2:
    v_max_u32 v13, v104, v106
    v_cmp_eq_u32 vcc, -1, v13
    s_cbranch_vccnz L_rt_2
    v_mfma_f32_16x16x32_bf16 v[40:43], v[216:219], v[104:107], v[40:43]
    ds_read_b64_tr_b16 v[216:217], v10 offset:40960
    ds_read_b64_tr_b16 v[218:219], v10 offset:42240
    v_mfma_f32_16x16x32_bf16 v[44:47], v[220:223], v[104:107], v[44:47]
    ds_read_b64_tr_b16 v[220:221], v10 offset:40992
    ds_read_b64_tr_b16 v[222:223], v10 offset:42272
    v_mfma_f32_16x16x32_bf16 v[48:51], v[224:227], v[104:107], v[48:51]
    ds_read_b64_tr_b16 v[224:225], v10 offset:41024
    ds_read_b64_tr_b16 v[226:227], v10 offset:42304
    v_mfma_f32_16x16x32_bf16 v[52:55], v[228:231], v[104:107], v[52:55]
    ds_read_b64_tr_b16 v[228:229], v10 offset:41056
    ds_read_b64_tr_b16 v[230:231], v10 offset:42336
    v_mfma_f32_16x16x32_bf16 v[56:59], v[232:235], v[104:107], v[56:59]
    ds_read_b64_tr_b16 v[232:233], v10 offset:41088
    ds_read_b64_tr_b16 v[234:235], v10 offset:42368
    s_waitcnt vmcnt(16) lgkmcnt(10)
L_chk_3:
    v_max_u32 v13, v108, v110
    v_cmp_eq_u32 vcc, -1, v13
    s_cbranch_vccnz L_rt_3
    v_mfma_f32_16x16x32_bf16 v[40:43], v[236:239], v[108:111], v[40:43]
    ds_read_b64_tr_b16 v[236:237], v10 offset:46080
    ds_read_b64_tr_b16 v[238:239], v10 offset:47360
    v_mfma_f32_16x16x32_bf16 v[44:47], v[240:243], v[108:111], v[44:47]
    ds_read_b64_tr_b16 v[240:241], v10 offset:46112
    ds_read_b64_tr_b16 v[242:243], v10 offset:47392
    v_mfma_f32_16x16x32_bf16 v[48:51], v[244:247], v[108:111], v[48:51]
    ds_read_b64_tr_b16 v[244:245], v10 offset:46144
    ds_read_b64_tr_b16 v[246:247], v10 offset:47424
    v_mfma_f32_16x16x32_bf16 v[52:55], v[248:251], v[108:111], v[52:55]
    ds_read_b64_tr_b16 v[248:249], v10 offset:46176
    ds_read_b64_tr_b16 v[250:251], v10 offset:47456
    v_mfma_f32_16x16x32_bf16 v[56:59], v[252:255], v[108:111], v[56:59]
    ds_read_b64_tr_b16 v[252:253], v10 offset:46208
    ds_read_b64_tr_b16 v[254:255], v10 offset:47488
    s_waitcnt vmcnt(15) lgkmcnt(10)
L_chk_4:
    v_max_u32 v13, v112, v114
    v_cmp_eq_u32 vcc, -1, v13
    s_cbranch_vccnz L_rt_4
    v_mfma_f32_16x16x32_bf16 v[40:43], v[60:63], v[112:115], v[40:43]
    ds_read_b64_tr_b16 v[60:61], v10 offset:51200
    ds_read_b64_tr_b16 v[62:63], v10 offset:52480
    v_mfma_f32_16x16x32_bf16 v[44:47], v[64:67], v[112:115], v[44:47]
    ds_read_b64_tr_b16 v[64:65], v10 offset:51232
    ds_read_b64_tr_b16 v[66:67], v10 offset:52512
    v_mfma_f32_16x16x32_bf16 v[48:51], v[68:71], v[112:115], v[48:51]
    ds_read_b64_tr_b16 v[68:69], v10 offset:51264
    ds_read_b64_tr_b16 v[70:71], v10 offset:52544
    v_mfma_f32_16x16x32_bf16 v[52:55], v[72:75], v[112:115], v[52:55]
    ds_read_b64_tr_b16 v[72:73], v10 offset:51296
    ds_read_b64_tr_b16 v[74:75], v10 offset:52576
    v_mfma_f32_16x16x32_bf16 v[56:59], v[76:79], v[112:115], v[56:59]
    ds_read_b64_tr_b16 v[76:77], v10 offset:51328
    ds_read_b64_tr_b16 v[78:79], v10 offset:52608
    s_waitcnt vmcnt(14) lgkmcnt(10)
L_chk_5:
    v_max_u32 v13, v116, v118
    v_cmp_eq_u32 vcc, -1, v13
    s_cbranch_vccnz L_rt_5
    v_mfma_f32_16x16x32_bf16 v[40:43], v[16:19], v[116:119], v[40:43]
    ds_read_b64_tr_b16 v[16:17], v10 offset:56320
    ds_read_b64_tr_b16 v[18:19], v10 offset:57600
    v_mfma_f32_16x16x32_bf16 v[44:47], v[20:23], v[116:119], v[44:47]
    ds_read_b64_tr_b16 v[20:21], v10 offset:56352
    ds_read_b64_tr_b16 v[22:23], v10 offset:57632
    v_mfma_f32_16x16x32_bf16 v[48:51], v[24:27], v[116:119], v[48:51]
    ds_read_b64_tr_b16 v[24:25], v10 offset:56384
    ds_read_b64_tr_b16 v[26:27], v10 offset:57664
    v_mfma_f32_16x16x32_bf16 v[52:55], v[28:31], v[116:119], v[52:55]
    ds_read_b64_tr_b16 v[28:29], v10 offset:56416
    ds_read_b64_tr_b16 v[30:31], v10 offset:57696
    v_mfma_f32_16x16x32_bf16 v[56:59], v[32:35], v[116:119], v[56:59]
    ds_read_b64_tr_b16 v[32:33], v10 offset:56448
    ds_read_b64_tr_b16 v[34:35], v10 offset:57728
    s_waitcnt vmcnt(13) lgkmcnt(10)
L_chk_6:
    v_max_u32 v13, v120, v122
    v_cmp_eq_u32 vcc, -1, v13
    s_cbranch_vccnz L_rt_6
    v_mfma_f32_16x16x32_bf16 v[40:43], v[176:179], v[120:123], v[40:43]
    ds_read_b64_tr_b16 v[176:177], v10 offset:61440
    ds_read_b64_tr_b16 v[178:179], v10 offset:62720
    v_mfma_f32_16x16x32_bf16 v[44:47], v[180:183], v[120:123], v[44:47]
    ds_read_b64_tr_b16 v[180:181], v10 offset:61472
    ds_read_b64_tr_b16 v[182:183], v10 offset:62752
    v_mfma_f32_16x16x32_bf16 v[48:51], v[184:187], v[120:123], v[48:51]
    ds_read_b64_tr_b16 v[184:185], v10 offset:61504
    ds_read_b64_tr_b16 v[186:187], v10 offset:62784
    v_mfma_f32_16x16x32_bf16 v[52:55], v[188:191], v[120:123], v[52:55]
    ds_read_b64_tr_b16 v[188:189], v10 offset:61536
    ds_read_b64_tr_b16 v[190:191], v10 offset:62816
    v_mfma_f32_16x16x32_bf16 v[56:59], v[192:195], v[120:123], v[56:59]
    ds_read_b64_tr_b16 v[192:193], v10 offset:61568
    ds_read_b64_tr_b16 v[194:195], v10 offset:62848
    s_waitcnt vmcnt(12) lgkmcnt(10)
L_chk_7:
    v_max_u32 v13, v124, v126
    v_cmp_eq_u32 vcc, -1, v13
    s_cbranch_vccnz L_rt_7
    v_mfma_f32_16x16x32_bf16 v[40:43], v[196:199], v[124:127], v[40:43]
    ds_read_b64_tr_b16 v[196:197], v11 offset:1024
    ds_read_b64_tr_b16 v[198:199], v11 offset:2304
    v_mfma_f32_16x16x32_bf16 v[44:47], v[200:203], v[124:127], v[44:47]
    ds_read_b64_tr_b16 v[200:201], v11 offset:1056
    ds_read_b64_tr_b16 v[202:203], v11 offset:2336
    v_mfma_f32_16x16x32_bf16 v[48:51], v[204:207], v[124:127], v[48:51]
    ds_read_b64_tr_b16 v[204:205], v11 offset:1088
    ds_read_b64_tr_b16 v[206:207], v11 offset:2368
    v_mfma_f32_16x16x32_bf16 v[52:55], v[208:211], v[124:127], v[52:55]
    ds_read_b64_tr_b16 v[208:209], v11 offset:1120
    ds_read_b64_tr_b16 v[210:211], v11 offset:2400
    v_mfma_f32_16x16x32_bf16 v[56:59], v[212:215], v[124:127], v[56:59]
    ds_read_b64_tr_b16 v[212:213], v11 offset:1152
    ds_read_b64_tr_b16 v[214:215], v11 offset:2432
    s_waitcnt vmcnt(11) lgkmcnt(10)
L_chk_8:
    v_max_u32 v13, v128, v130
    v_cmp_eq_u32 vcc, -1, v13
    s_cbranch_vccnz L_rt_8
    v_mfma_f32_16x16x32_bf16 v[40:43], v[216:219], v[128:131], v[40:43]
    ds_read_b64_tr_b16 v[216:217], v11 offset:6144
    ds_read_b64_tr_b16 v[218:219], v11 offset:7424
    v_mfma_f32_16x16x32_bf16 v[44:47], v[220:223], v[128:131], v[44:47]
    ds_read_b64_tr_b16 v[220:221], v11 offset:6176
    ds_read_b64_tr_b16 v[222:223], v11 offset:7456
    v_mfma_f32_16x16x32_bf16 v[48:51], v[224:227], v[128:131], v[48:51]
    ds_read_b64_tr_b16 v[224:225], v11 offset:6208
    ds_read_b64_tr_b16 v[226:227], v11 offset:7488
    v_mfma_f32_16x16x32_bf16 v[52:55], v[228:231], v[128:131], v[52:55]
    ds_read_b64_tr_b16 v[228:229], v11 offset:6240
    ds_read_b64_tr_b16 v[230:231], v11 offset:7520
    v_mfma_f32_16x16x32_bf16 v[56:59], v[232:235], v[128:131], v[56:59]
    ds_read_b64_tr_b16 v[232:233], v11 offset:6272
    ds_read_b64_tr_b16 v[234:235], v11 offset:7552
    s_waitcnt vmcnt(10) lgkmcnt(10)
L_chk_9:
    v_max_u32 v13, v132, v134
    v_cmp_eq_u32 vcc, -1, v13
    s_cbranch_vccnz L_rt_9
    v_mfma_f32_16x16x32_bf16 v[40:43], v[236:239], v[132:135], v[40:43]
    ds_read_b64_tr_b16 v[236:237], v11 offset:11264
    ds_read_b64_tr_b16 v[238:239], v11 offset:12544
    v_mfma_f32_16x16x32_bf16 v[44:47], v[240:243], v[132:135], v[44:47]
    ds_read_b64_tr_b16 v[240:241], v11 offset:11296
    ds_read_b64_tr_b16 v[242:243], v11 offset:12576
    v_mfma_f32_16x16x32_bf16 v[48:51], v[244:247], v[132:135], v[48:51]
    ds_read_b64_tr_b16 v[244:245], v11 offset:11328
    ds_read_b64_tr_b16 v[246:247], v11 offset:12608
    v_mfma_f32_16x16x32_bf16 v[52:55], v[248:251], v[132:135], v[52:55]
    ds_read_b64_tr_b16 v[248:249], v11 offset:11360
    ds_read_b64_tr_b16 v[250:251], v11 offset:12640
    v_mfma_f32_16x16x32_bf16 v[56:59], v[252:255], v[132:135], v[56:59]
    ds_read_b64_tr_b16 v[252:253], v11 offset:11392
    ds_read_b64_tr_b16 v[254:255], v11 offset:12672
    s_cmp_eq_u32 s68, 2
    s_cbranch_scc1 L_s2_have
L_s2_chk:
    s_waitcnt vmcnt(0)
    v_cmp_eq_u32 vcc, -1, v3
    s_and_b64 vcc, vcc, s[42:43]
    s_cbranch_vccz L_s2_go
    s_sub_u32 s60, s60, 1
    s_cbranch_scc1 L_end
    buffer_load_dword v3, v2, s[28:31], s44 offen sc1
    s_branch L_s2_chk
L_s2_go:
    s_add_u32 s40, s44, 8192
    buffer_load_dwordx4 v[136:139], v7, s[28:31], s40 offen offset:2048 sc1
    buffer_load_dwordx4 v[140:143], v7, s[28:31], s40 offen offset:3072 sc1
    s_add_u32 s40, s40, 4096
    buffer_load_dwordx4 v[144:147], v7, s[28:31], s40 offen offset:0 sc1
    buffer_load_dwordx4 v[148:151], v7, s[28:31], s40 offen offset:1024 sc1
    buffer_load_dwordx4 v[152:155], v7, s[28:31], s40 offen offset:2048 sc1
    buffer_load_dwordx4 v[156:159], v7, s[28:31], s40 offen offset:3072 sc1
    s_add_u32 s40, s40, 4096
    buffer_load_dwordx4 v[160:163], v7, s[28:31], s40 offen offset:0 sc1
    buffer_load_dwordx4 v[164:167], v7, s[28:31], s40 offen offset:1024 sc1
    buffer_load_dwordx4 v[168:171], v7, s[28:31], s40 offen offset:2048 sc1
    buffer_load_dwordx4 v[172:175], v7, s[28:31], s40 offen offset:3072 sc1
    s_add_u32 s40, s40, 4096
L_s2_have:
    s_waitcnt vmcnt(9) lgkmcnt(10)
L_chk_10:
    v_max_u32 v13, v136, v138
    v_cmp_eq_u32 vcc, -1, v13
    s_cbranch_vccnz L_rt_10
    v_mfma_f32_16x16x32_bf16 v[40:43], v[60:63], v[136:139], v[40:43]
    ds_read_b64_tr_b16 v[60:61], v11 offset:16384
    ds_read_b64_tr_b16 v[62:63], v11 offset:17664
    v_mfma_f32_16x16x32_bf16 v[44:47], v[64:67], v[136:139], v[44:47]
    ds_read_b64_tr_b16 v[64:65], v11 offset:16416
    ds_read_b64_tr_b16 v[66:67], v11 offset:17696
    v_mfma_f32_16x16x32_bf16 v[48:51], v[68:71], v[136:139], v[48:51]
    ds_read_b64_tr_b16 v[68:69], v11 offset:16448
    ds_read_b64_tr_b16 v[70:71], v11 offset:17728
    v_mfma_f32_16x16x32_bf16 v[52:55], v[72:75], v[136:139], v[52:55]
    ds_read_b64_tr_b16 v[72:73], v11 offset:16480
    ds_read_b64_tr_b16 v[74:75], v11 offset:17760
    v_mfma_f32_16x16x32_bf16 v[56:59], v[76:79], v[136:139], v[56:59]
    ds_read_b64_tr_b16 v[76:77], v11 offset:16512
    ds_read_b64_tr_b16 v[78:79], v11 offset:17792
    s_waitcnt vmcnt(8) lgkmcnt(10)
L_chk_11:
    v_max_u32 v13, v140, v142
    v_cmp_eq_u32 vcc, -1, v13
    s_cbranch_vccnz L_rt_11
    v_mfma_f32_16x16x32_bf16 v[40:43], v[16:19], v[140:143], v[40:43]
    ds_read_b64_tr_b16 v[16:17], v11 offset:21504
    ds_read_b64_tr_b16 v[18:19], v11 offset:22784
    v_mfma_f32_16x16x32_bf16 v[44:47], v[20:23], v[140:143], v[44:47]
    ds_read_b64_tr_b16 v[20:21], v11 offset:21536
    ds_read_b64_tr_b16 v[22:23], v11 offset:22816
    v_mfma_f32_16x16x32_bf16 v[48:51], v[24:27], v[140:143], v[48:51]
    ds_read_b64_tr_b16 v[24:25], v11 offset:21568
    ds_read_b64_tr_b16 v[26:27], v11 offset:22848
    v_mfma_f32_16x16x32_bf16 v[52:55], v[28:31], v[140:143], v[52:55]
    ds_read_b64_tr_b16 v[28:29], v11 offset:21600
    ds_read_b64_tr_b16 v[30:31], v11 offset:22880
    v_mfma_f32_16x16x32_bf16 v[56:59], v[32:35], v[140:143], v[56:59]
    ds_read_b64_tr_b16 v[32:33], v11 offset:21632
    ds_read_b64_tr_b16 v[34:35], v11 offset:22912
    s_waitcnt vmcnt(7) lgkmcnt(10)
L_chk_12:
    v_max_u32 v13, v144, v146
    v_cmp_eq_u32 vcc, -1, v13
    s_cbranch_vccnz L_rt_12
    v_mfma_f32_16x16x32_bf16 v[40:43], v[176:179], v[144:147], v[40:43]
    ds_read_b64_tr_b16 v[176:177], v11 offset:26624
    ds_read_b64_tr_b16 v[178:179], v11 offset:27904
    v_mfma_f32_16x16x32_bf16 v[44:47], v[180:183], v[144:147], v[44:47]
    ds_read_b64_tr_b16 v[180:181], v11 offset:26656
    ds_read_b64_tr_b16 v[182:183], v11 offset:27936
    v_mfma_f32_16x16x32_bf16 v[48:51], v[184:187], v[144:147], v[48:51]
    ds_read_b64_tr_b16 v[184:185], v11 offset:26688
    ds_read_b64_tr_b16 v[186:187], v11 offset:27968
    v_mfma_f32_16x16x32_bf16 v[52:55], v[188:191], v[144:147], v[52:55]
    ds_read_b64_tr_b16 v[188:189], v11 offset:26720
    ds_read_b64_tr_b16 v[190:191], v11 offset:28000
    v_mfma_f32_16x16x32_bf16 v[56:59], v[192:195], v[144:147], v[56:59]
    ds_read_b64_tr_b16 v[192:193], v11 offset:26752
    ds_read_b64_tr_b16 v[194:195], v11 offset:28032
    s_waitcnt vmcnt(6) lgkmcnt(10)
L_chk_13:
    v_max_u32 v13, v148, v150
    v_cmp_eq_u32 vcc, -1, v13
    s_cbranch_vccnz L_rt_13
    v_mfma_f32_16x16x32_bf16 v[40:43], v[196:199], v[148:151], v[40:43]
    ds_read_b64_tr_b16 v[196:197], v12 offset:27392
    ds_read_b64_tr_b16 v[198:199], v12 offset:28672
    v_mfma_f32_16x16x32_bf16 v[44:47], v[200:203], v[148:151], v[44:47]
    ds_read_b64_tr_b16 v[200:201], v12 offset:27424
    ds_read_b64_tr_b16 v[202:203], v12 offset:28704
    v_mfma_f32_16x16x32_bf16 v[48:51], v[204:207], v[148:151], v[48:51]
    ds_read_b64_tr_b16 v[204:205], v12 offset:27456
    ds_read_b64_tr_b16 v[206:207], v12 offset:28736
    v_mfma_f32_16x16x32_bf16 v[52:55], v[208:211], v[148:151], v[52:55]
    ds_read_b64_tr_b16 v[208:209], v12 offset:27488
    ds_read_b64_tr_b16 v[210:211], v12 offset:28768
    v_mfma_f32_16x16x32_bf16 v[56:59], v[212:215], v[148:151], v[56:59]
    ds_read_b64_tr_b16 v[212:213], v12 offset:27520
    ds_read_b64_tr_b16 v[214:215], v12 offset:28800
    s_waitcnt vmcnt(5) lgkmcnt(10)
L_chk_14:
    v_max_u32 v13, v152, v154
    v_cmp_eq_u32 vcc, -1, v13
    s_cbranch_vccnz L_rt_14
    v_mfma_f32_16x16x32_bf16 v[40:43], v[216:219], v[152:155], v[40:43]
    v_mfma_f32_16x16x32_bf16 v[44:47], v[220:223], v[152:155], v[44:47]
    v_mfma_f32_16x16x32_bf16 v[48:51], v[224:227], v[152:155], v[48:51]
    v_mfma_f32_16x16x32_bf16 v[52:55], v[228:231], v[152:155], v[52:55]
    v_mfma_f32_16x16x32_bf16 v[56:59], v[232:235], v[152:155], v[56:59]
    s_waitcnt vmcnt(4) lgkmcnt(0)
L_chk_15:
    v_max_u32 v13, v156, v158
    v_cmp_eq_u32 vcc, -1, v13
    s_cbranch_vccnz L_rt_15
    v_mfma_f32_16x16x32_bf16 v[40:43], v[236:239], v[156:159], v[40:43]
    v_mfma_f32_16x16x32_bf16 v[44:47], v[240:243], v[156:159], v[44:47]
    v_mfma_f32_16x16x32_bf16 v[48:51], v[244:247], v[156:159], v[48:51]
    v_mfma_f32_16x16x32_bf16 v[52:55], v[248:251], v[156:159], v[52:55]
    v_mfma_f32_16x16x32_bf16 v[56:59], v[252:255], v[156:159], v[56:59]
    s_waitcnt vmcnt(3) lgkmcnt(0)
L_chk_16:
    v_max_u32 v13, v160, v162
    v_cmp_eq_u32 vcc, -1, v13
    s_cbranch_vccnz L_rt_16
    v_mfma_f32_16x16x32_bf16 v[40:43], v[60:63], v[160:163], v[40:43]
    v_mfma_f32_16x16x32_bf16 v[44:47], v[64:67], v[160:163], v[44:47]
    v_mfma_f32_16x16x32_bf16 v[48:51], v[68:71], v[160:163], v[48:51]
    v_mfma_f32_16x16x32_bf16 v[52:55], v[72:75], v[160:163], v[52:55]
    v_mfma_f32_16x16x32_bf16 v[56:59], v[76:79], v[160:163], v[56:59]
    s_waitcnt vmcnt(2) lgkmcnt(0)
L_chk_17:
    v_max_u32 v13, v164, v166
    v_cmp_eq_u32 vcc, -1, v13
    s_cbranch_vccnz L_rt_17
    v_mfma_f32_16x16x32_bf16 v[40:43], v[16:19], v[164:167], v[40:43]
    v_mfma_f32_16x16x32_bf16 v[44:47], v[20:23], v[164:167], v[44:47]
    v_mfma_f32_16x16x32_bf16 v[48:51], v[24:27], v[164:167], v[48:51]
    v_mfma_f32_16x16x32_bf16 v[52:55], v[28:31], v[164:167], v[52:55]
    v_mfma_f32_16x16x32_bf16 v[56:59], v[32:35], v[164:167], v[56:59]
    s_waitcnt vmcnt(1) lgkmcnt(0)
L_chk_18:
    v_max_u32 v13, v168, v170
    v_cmp_eq_u32 vcc, -1, v13
    s_cbranch_vccnz L_rt_18
    v_mfma_f32_16x16x32_bf16 v[40:43], v[176:179], v[168:171], v[40:43]
    v_mfma_f32_16x16x32_bf16 v[44:47], v[180:183], v[168:171], v[44:47]
    v_mfma_f32_16x16x32_bf16 v[48:51], v[184:187], v[168:171], v[48:51]
    v_mfma_f32_16x16x32_bf16 v[52:55], v[188:191], v[168:171], v[52:55]
    v_mfma_f32_16x16x32_bf16 v[56:59], v[192:195], v[168:171], v[56:59]
    s_waitcnt vmcnt(0) lgkmcnt(0)
L_chk_19:
    v_max_u32 v13, v172, v174
    v_cmp_eq_u32 vcc, -1, v13
    s_cbranch_vccnz L_rt_19
    v_mfma_f32_16x16x32_bf16 v[40:43], v[196:199], v[172:175], v[40:43]
    v_mfma_f32_16x16x32_bf16 v[44:47], v[200:203], v[172:175], v[44:47]
    v_mfma_f32_16x16x32_bf16 v[48:51], v[204:207], v[172:175], v[48:51]
    v_mfma_f32_16x16x32_bf16 v[52:55], v[208:211], v[172:175], v[52:55]
    v_mfma_f32_16x16x32_bf16 v[56:59], v[212:215], v[172:175], v[56:59]
    s_mov_b32 s76, s12
    s_and_b32 s77, s13, 0xffff
    s_mov_b32 s78, 2621440
    s_mov_b32 s79, 0x20000
    v_and_b32 v2, 15, v0
    v_lshrrev_b32 v3, 4, v0
    s_lshl_b32 s40, s46, 4
    v_add_u32 v2, s40, v2
    v_mul_u32_u24 v2, 1280, v2
    v_lshlrev_b32 v4, 3, v3
    v_add_u32 v2, v2, v4
    s_lshr_b32 s40, s35, 1
    s_mul_i32 s40, s40, 160
    v_cvt_pk_bf16_f32 v64, v40, v41
    v_cvt_pk_bf16_f32 v65, v42, v43
    v_cvt_pk_bf16_f32 v66, v44, v45
    v_cvt_pk_bf16_f32 v67, v46, v47
    v_cvt_pk_bf16_f32 v68, v48, v49
    v_cvt_pk_bf16_f32 v69, v50, v51
    v_cvt_pk_bf16_f32 v70, v52, v53
    v_cvt_pk_bf16_f32 v71, v54, v55
    v_cvt_pk_bf16_f32 v72, v56, v57
    v_cvt_pk_bf16_f32 v73, v58, v59
    buffer_store_dwordx2 v[64:65], v2, s[76:79], s40 offen offset:0
    buffer_store_dwordx2 v[66:67], v2, s[76:79], s40 offen offset:32
    buffer_store_dwordx2 v[68:69], v2, s[76:79], s40 offen offset:64
    buffer_store_dwordx2 v[70:71], v2, s[76:79], s40 offen offset:96
    buffer_store_dwordx2 v[72:73], v2, s[76:79], s40 offen offset:128
    s_branch L_fin
L_rt_0:
    s_sub_u32 s60, s60, 1
    s_cbranch_scc1 L_end
    s_add_u32 s40, s44, 0
    buffer_load_dwordx4 v[96:99], v7, s[28:31], s40 offen sc1
    s_waitcnt vmcnt(0)
    s_branch L_chk_0
L_rt_1:
    s_sub_u32 s60, s60, 1
    s_cbranch_scc1 L_end
    s_add_u32 s40, s44, 1024
    buffer_load_dwordx4 v[100:103], v7, s[28:31], s40 offen sc1
    s_waitcnt vmcnt(0)
    s_branch L_chk_1
L_rt_2:
    s_sub_u32 s60, s60, 1
    s_cbranch_scc1 L_end
    s_add_u32 s40, s44, 2048
    buffer_load_dwordx4 v[104:107], v7, s[28:31], s40 offen sc1
    s_waitcnt vmcnt(0)
    s_branch L_chk_2
L_rt_3:
    s_sub_u32 s60, s60, 1
    s_cbranch_scc1 L_end
    s_add_u32 s40, s44, 3072
    buffer_load_dwordx4 v[108:111], v7, s[28:31], s40 offen sc1
    s_waitcnt vmcnt(0)
    s_branch L_chk_3
L_rt_4:
    s_sub_u32 s60, s60, 1
    s_cbranch_scc1 L_end
    s_add_u32 s40, s44, 4096
    buffer_load_dwordx4 v[112:115], v7, s[28:31], s40 offen sc1
    s_waitcnt vmcnt(0)
    s_branch L_chk_4
L_rt_5:
    s_sub_u32 s60, s60, 1
    s_cbranch_scc1 L_end
    s_add_u32 s40, s44, 5120
    buffer_load_dwordx4 v[116:119], v7, s[28:31], s40 offen sc1
    s_waitcnt vmcnt(0)
    s_branch L_chk_5
L_rt_6:
    s_sub_u32 s60, s60, 1
    s_cbranch_scc1 L_end
    s_add_u32 s40, s44, 6144
    buffer_load_dwordx4 v[120:123], v7, s[28:31], s40 offen sc1
    s_waitcnt vmcnt(0)
    s_branch L_chk_6
L_rt_7:
    s_sub_u32 s60, s60, 1
    s_cbranch_scc1 L_end
    s_add_u32 s40, s44, 7168
    buffer_load_dwordx4 v[124:127], v7, s[28:31], s40 offen sc1
    s_waitcnt vmcnt(0)
    s_branch L_chk_7
L_rt_8:
    s_sub_u32 s60, s60, 1
    s_cbranch_scc1 L_end
    s_add_u32 s40, s44, 8192
    buffer_load_dwordx4 v[128:131], v7, s[28:31], s40 offen sc1
    s_waitcnt vmcnt(0)
    s_branch L_chk_8
L_rt_9:
    s_sub_u32 s60, s60, 1
    s_cbranch_scc1 L_end
    s_add_u32 s40, s44, 9216
    buffer_load_dwordx4 v[132:135], v7, s[28:31], s40 offen sc1
    s_waitcnt vmcnt(0)
    s_branch L_chk_9
L_rt_10:
    s_sub_u32 s60, s60, 1
    s_cbranch_scc1 L_end
    s_add_u32 s40, s44, 10240
    buffer_load_dwordx4 v[136:139], v7, s[28:31], s40 offen sc1
    s_waitcnt vmcnt(0)
    s_branch L_chk_10
L_rt_11:
    s_sub_u32 s60, s60, 1
    s_cbranch_scc1 L_end
    s_add_u32 s40, s44, 11264
    buffer_load_dwordx4 v[140:143], v7, s[28:31], s40 offen sc1
    s_waitcnt vmcnt(0)
    s_branch L_chk_11
L_rt_12:
    s_sub_u32 s60, s60, 1
    s_cbranch_scc1 L_end
    s_add_u32 s40, s44, 12288
    buffer_load_dwordx4 v[144:147], v7, s[28:31], s40 offen sc1
    s_waitcnt vmcnt(0)
    s_branch L_chk_12
L_rt_13:
    s_sub_u32 s60, s60, 1
    s_cbranch_scc1 L_end
    s_add_u32 s40, s44, 13312
    buffer_load_dwordx4 v[148:151], v7, s[28:31], s40 offen sc1
    s_waitcnt vmcnt(0)
    s_branch L_chk_13
L_rt_14:
    s_sub_u32 s60, s60, 1
    s_cbranch_scc1 L_end
    s_add_u32 s40, s44, 14336
    buffer_load_dwordx4 v[152:155], v7, s[28:31], s40 offen sc1
    s_waitcnt vmcnt(0)
    s_branch L_chk_14
L_rt_15:
    s_sub_u32 s60, s60, 1
    s_cbranch_scc1 L_end
    s_add_u32 s40, s44, 15360
    buffer_load_dwordx4 v[156:159], v7, s[28:31], s40 offen sc1
    s_waitcnt vmcnt(0)
    s_branch L_chk_15
L_rt_16:
    s_sub_u32 s60, s60, 1
    s_cbranch_scc1 L_end
    s_add_u32 s40, s44, 16384
    buffer_load_dwordx4 v[160:163], v7, s[28:31], s40 offen sc1
    s_waitcnt vmcnt(0)
    s_branch L_chk_16
L_rt_17:
    s_sub_u32 s60, s60, 1
    s_cbranch_scc1 L_end
    s_add_u32 s40, s44, 17408
    buffer_load_dwordx4 v[164:167], v7, s[28:31], s40 offen sc1
    s_waitcnt vmcnt(0)
    s_branch L_chk_17
L_rt_18:
    s_sub_u32 s60, s60, 1
    s_cbranch_scc1 L_end
    s_add_u32 s40, s44, 18432
    buffer_load_dwordx4 v[168:171], v7, s[28:31], s40 offen sc1
    s_waitcnt vmcnt(0)
    s_branch L_chk_18
L_rt_19:
    s_sub_u32 s60, s60, 1
    s_cbranch_scc1 L_end
    s_add_u32 s40, s44, 19456
    buffer_load_dwordx4 v[172:175], v7, s[28:31], s40 offen sc1
    s_waitcnt vmcnt(0)
    s_branch L_chk_19
L_lq:
    v_lshrrev_b32 v2, 3, v0
    s_lshl_b32 s40, s33, 3
    v_add_u32 v2, s40, v2
    v_mul_u32_u24 v2, 1280, v2
    v_lshrrev_b32 v3, 4, v0
    s_and_b32 s40, s33, 1
    s_lshl_b32 s40, s40, 2
    v_add_u32 v4, s40, v3
    v_and_b32 v5, 7, v0
    v_xor_b32 v5, v5, v4
    v_lshlrev_b32 v5, 4, v5
    v_add_u32 v10, v2, v5
    v_and_b32 v4, 15, v0
    v_lshlrev_b32 v5, 2, v3
    v_sub_u32 v4, v4, v5
    v_and_b32 v4, 15, v4
    v_lshrrev_b32 v5, 3, v4
    v_bfe_u32 v6, v4, 2, 1
    v_and_b32 v7, 3, v4
    v_mul_lo_u32 v8, v6, s36
    v_add_u32 v8, v8, v7
    v_mov_b32 v9, 5
    v_mov_b32 v13, s36
    v_cmp_eq_u32 vcc, 0, v6
    s_lshl_b32 s40, s33, 2
    v_add_u32 v2, s40, v3
    v_cndmask_b32 v9, v9, v13, vcc
    v_cmp_lt_u32 vcc, v8, v9
    v_mul_u32_u24 v2, 3840, v2
    v_add_u32 v5, 1, v5
    v_mul_u32_u24 v5, 1280, v5
    v_lshlrev_b32 v8, 4, v8
    v_add3_u32 v11, v2, v5, v8
    v_mov_b32 v7, 0x40000000
    v_cndmask_b32 v11, v7, v11, vcc
    s_mul_i32 s52, s34, 163840
    s_mul_i32 s53, s35, 80
    s_lshl_b32 s54, s33, 10
    s_waitcnt lgkmcnt(0)
    s_mov_b32 s20, s4
    s_and_b32 s21, s5, 0xffff
    s_mov_b32 s22, 2621440
    s_mov_b32 s23, 0x20000
    s_mov_b32 s24, s6
    s_and_b32 s25, s7, 0xffff
    s_mov_b32 s26, 2457600
    s_mov_b32 s27, 0x20000
    s_add_u32 m0, s54, 0
    s_add_u32 s40, s52, 0
    buffer_load_dwordx4 v10, s[20:23], s40 offen lds
    s_add_u32 m0, s54, 16384
    s_add_u32 s40, s53, 0
    buffer_load_dwordx4 v11, s[24:27], s40 offen lds
    s_add_u32 m0, s54, 4096
    s_add_u32 s40, s52, 40960
    buffer_load_dwordx4 v10, s[20:23], s40 offen lds
    s_add_u32 m0, s54, 20480
    s_add_u32 s40, s53, 61440
    buffer_load_dwordx4 v11, s[24:27], s40 offen lds
    s_add_u32 m0, s54, 8192
    s_add_u32 s40, s52, 81920
    buffer_load_dwordx4 v10, s[20:23], s40 offen lds
    s_add_u32 m0, s54, 24576
    s_add_u32 s40, s53, 122880
    buffer_load_dwordx4 v11, s[24:27], s40 offen lds
    s_add_u32 m0, s54, 12288
    s_add_u32 s40, s52, 122880
    buffer_load_dwordx4 v10, s[20:23], s40 offen lds
    s_add_u32 m0, s54, 28672
    s_add_u32 s40, s53, 184320
    buffer_load_dwordx4 v11, s[24:27], s40 offen lds
    s_mov_b32 s72, s8
    s_and_b32 s73, s9, 0xffff
    s_mov_b32 s74, 25600
    s_mov_b32 s75, 0x20000
    v_lshlrev_b32 v2, 4, v0
    s_and_b32 s40, s33, 1
    s_lshl_b32 s40, s40, 10
    s_add_u32 m0, s40, 149504
    s_mul_i32 s41, s35, 1600
    s_add_u32 s40, s40, s41
    buffer_load_dwordx4 v2, s[72:75], s40 offen lds
    s_add_u32 m0, s54, 32768
    s_add_u32 s40, s52, 128
    buffer_load_dwordx4 v10, s[20:23], s40 offen lds
    s_add_u32 m0, s54, 49152
    s_add_u32 s40, s53, 245760
    buffer_load_dwordx4 v11, s[24:27], s40 offen lds
    s_add_u32 m0, s54, 36864
    s_add_u32 s40, s52, 41088
    buffer_load_dwordx4 v10, s[20:23], s40 offen lds
    s_add_u32 m0, s54, 53248
    s_add_u32 s40, s53, 307200
    buffer_load_dwordx4 v11, s[24:27], s40 offen lds
    s_add_u32 m0, s54, 40960
    s_add_u32 s40, s52, 82048
    buffer_load_dwordx4 v10, s[20:23], s40 offen lds
    s_add_u32 m0, s54, 57344
    s_add_u32 s40, s53, 368640
    buffer_load_dwordx4 v11, s[24:27], s40 offen lds
    s_add_u32 m0, s54, 45056
    s_add_u32 s40, s52, 123008
    buffer_load_dwordx4 v10, s[20:23], s40 offen lds
    s_add_u32 m0, s54, 61440
    s_add_u32 s40, s53, 430080
    buffer_load_dwordx4 v11, s[24:27], s40 offen lds
    s_mov_b32 s28, s16
    s_and_b32 s29, s17, 0xffff
    s_mov_b32 s30, 268435456
    s_mov_b32 s31, 0x20000
    s_lshl_b32 s64, s35, 4
    s_add_u32 s64, s64, s34
    s_lshl_b32 s64, s64, 12
    s_add_u32 s64, s64, 0
    v_mov_b32 v40, -1
    v_mov_b32 v41, -1
    v_mov_b32 v42, -1
    v_mov_b32 v43, -1
    s_lshl_b32 s40, s33, 6
    v_add_u32 v2, s40, v0
    v_lshlrev_b32 v8, 4, v2
    v_mov_b32 v3, 0x40000000
    v_cmp_gt_u32 vcc, 240, v2
    v_lshrrev_b32 v9, 4, v0
    v_and_b32 v44, 15, v0
    v_cndmask_b32 v8, v3, v8, vcc
    v_lshlrev_b32 v44, 4, v44
    s_lshl_b32 s40, s34, 3
    s_lshl_b32 s41, s33, 1
    s_add_u32 s40, s40, s41
    s_mul_i32 s40, s40, 20480
    s_mul_i32 s41, s66, 5120
    s_add_u32 s40, s40, s41
    s_lshl_b32 s41, s67, 8
    s_add_u32 s40, s40, s41
    s_add_u32 s43, s40, 1048576
    v_lshlrev_b32 v45, 10, v9
    v_add_u32 v45, v45, v44
    v_mov_b32 v46, 4096
    v_add_u32 v47, -1, v9
    v_lshlrev_b32 v47, 10, v47
    v_add_u32 v47, 20480, v47
    v_cmp_eq_u32 vcc, 0, v9
    s_nop 1
    v_cndmask_b32 v46, v47, v46, vcc
    v_add_u32 v46, v46, v44
    v_add_u32 v47, 3, v9
    v_lshlrev_b32 v47, 10, v47
    v_add_u32 v47, 20480, v47
    v_add_u32 v47, v47, v44
    v_cmp_gt_u32 vcc, 2, v9
    s_nop 1
    v_cndmask_b32 v47, v3, v47, vcc
    buffer_store_dwordx4 v[40:43], v8, s[28:31], s64 offen sc1
    buffer_store_dwordx4 v[40:43], v45, s[28:31], s43 offen sc1
    buffer_store_dwordx4 v[40:43], v46, s[28:31], s43 offen sc1
    buffer_store_dwordx4 v[40:43], v47, s[28:31], s43 offen sc1
    v_and_b32 v2, 31, v0
    v_lshrrev_b32 v3, 5, v0
    v_bfe_u32 v4, v2, 1, 3
    v_xor_b32 v4, v4, v3
    v_lshlrev_b32 v4, 4, v4
    s_lshl_b32 s40, s33, 5
    v_add_u32 v2, s40, v2
    v_lshlrev_b32 v2, 7, v2
    v_add_u32 v14, v2, v4
    v_xor_b32 v15, 32, v14
    v_xor_b32 v16, 64, v14
    v_xor_b32 v17, 96, v14
    v_add_u32 v2, 0, v0
    v_mul_u32_u24 v3, 205, v2
    v_lshrrev_b32 v3, 10, v3
    v_mul_u32_u24 v4, 5, v3
    v_sub_u32 v4, v2, v4
    v_lshlrev_b32 v4, 4, v4
    v_mul_u32_u24 v3, 3840, v3
    v_add_u32 v12, v3, v4
    v_add_u32 v2, 64, v0
    v_mul_u32_u24 v3, 205, v2
    v_lshrrev_b32 v3, 10, v3
    v_mul_u32_u24 v4, 5, v3
    v_sub_u32 v4, v2, v4
    v_lshlrev_b32 v4, 4, v4
    v_mul_u32_u24 v3, 3840, v3
    v_add_u32 v13, v3, v4
    v_add_u32 v2, 128, v0
    v_mul_u32_u24 v3, 205, v2
    v_lshrrev_b32 v3, 10, v3
    v_mul_u32_u24 v4, 5, v3
    v_sub_u32 v4, v2, v4
    v_lshlrev_b32 v4, 4, v4
    v_mul_u32_u24 v3, 3840, v3
    v_add_u32 v22, v3, v4
    v_add_u32 v2, 192, v0
    v_mul_u32_u24 v3, 205, v2
    v_lshrrev_b32 v3, 10, v3
    v_mul_u32_u24 v4, 5, v3
    v_sub_u32 v4, v2, v4
    v_lshlrev_b32 v4, 4, v4
    v_mul_u32_u24 v3, 3840, v3
    v_add_u32 v23, v3, v4
    v_add_u32 v2, 256, v0
    v_mul_u32_u24 v3, 205, v2
    v_lshrrev_b32 v3, 10, v3
    v_mul_u32_u24 v4, 5, v3
    v_sub_u32 v4, v2, v4
    v_lshlrev_b32 v4, 4, v4
    v_mul_u32_u24 v3, 3840, v3
    v_add_u32 v62, v3, v4
    s_waitcnt vmcnt(12) lgkmcnt(0)
    s_barrier
    ds_read_b128 v[64:67], v14 offset:0
    ds_read_b128 v[68:71], v15 offset:0
    ds_read_b128 v[72:75], v16 offset:0
    ds_read_b128 v[76:79], v17 offset:0
    s_add_u32 m0, s54, 65536
    s_add_u32 s40, s52, 256
    buffer_load_dwordx4 v10, s[20:23], s40 offen lds
    s_add_u32 m0, s54, 81920
    s_add_u32 s40, s53, 491520
    buffer_load_dwordx4 v11, s[24:27], s40 offen lds
    s_add_u32 m0, s54, 69632
    s_add_u32 s40, s52, 41216
    buffer_load_dwordx4 v10, s[20:23], s40 offen lds
    s_add_u32 m0, s54, 86016
    s_add_u32 s40, s53, 552960
    buffer_load_dwordx4 v11, s[24:27], s40 offen lds
    s_add_u32 m0, s54, 73728
    s_add_u32 s40, s52, 82176
    buffer_load_dwordx4 v10, s[20:23], s40 offen lds
    s_add_u32 m0, s54, 90112
    s_add_u32 s40, s53, 614400
    buffer_load_dwordx4 v11, s[24:27], s40 offen lds
    s_add_u32 m0, s54, 77824
    s_add_u32 s40, s52, 123136
    buffer_load_dwordx4 v10, s[20:23], s40 offen lds
    s_add_u32 m0, s54, 94208
    s_add_u32 s40, s53, 675840
    buffer_load_dwordx4 v11, s[24:27], s40 offen lds
    s_waitcnt vmcnt(12) lgkmcnt(0)
    s_barrier
    ds_read_b128 v[80:83], v14 offset:32768
    ds_read_b128 v[84:87], v15 offset:32768
    ds_read_b128 v[88:91], v16 offset:32768
    ds_read_b128 v[92:95], v17 offset:32768
    s_add_u32 m0, s54, 0
    s_add_u32 s40, s52, 384
    buffer_load_dwordx4 v10, s[20:23], s40 offen lds
    s_add_u32 m0, s54, 16384
    s_add_u32 s40, s53, 737280
    buffer_load_dwordx4 v11, s[24:27], s40 offen lds
    s_add_u32 m0, s54, 4096
    s_add_u32 s40, s52, 41344
    buffer_load_dwordx4 v10, s[20:23], s40 offen lds
    s_add_u32 m0, s54, 20480
    s_add_u32 s40, s53, 798720
    buffer_load_dwordx4 v11, s[24:27], s40 offen lds
    s_add_u32 m0, s54, 8192
    s_add_u32 s40, s52, 82304
    buffer_load_dwordx4 v10, s[20:23], s40 offen lds
    s_add_u32 m0, s54, 24576
    s_add_u32 s40, s53, 860160
    buffer_load_dwordx4 v11, s[24:27], s40 offen lds
    s_add_u32 m0, s54, 12288
    s_add_u32 s40, s52, 123264
    buffer_load_dwordx4 v10, s[20:23], s40 offen lds
    s_add_u32 m0, s54, 28672
    s_add_u32 s40, s53, 921600
    buffer_load_dwordx4 v11, s[24:27], s40 offen lds
    s_waitcnt vmcnt(8) lgkmcnt(0)
    s_barrier
    v_add_u32 v14, 65536, v14
    v_add_u32 v15, 65536, v15
    v_add_u32 v16, 65536, v16
    v_add_u32 v17, 65536, v17
    ds_read_b128 v[96:99], v14 offset:0
    ds_read_b128 v[100:103], v15 offset:0
    ds_read_b128 v[104:107], v16 offset:0
    ds_read_b128 v[108:111], v17 offset:0
    s_add_u32 m0, s54, 32768
    s_add_u32 s40, s52, 512
    buffer_load_dwordx4 v10, s[20:23], s40 offen lds
    s_add_u32 m0, s54, 49152
    s_add_u32 s40, s53, 983040
    buffer_load_dwordx4 v11, s[24:27], s40 offen lds
    s_add_u32 m0, s54, 36864
    s_add_u32 s40, s52, 41472
    buffer_load_dwordx4 v10, s[20:23], s40 offen lds
    s_add_u32 m0, s54, 53248
    s_add_u32 s40, s53, 1044480
    buffer_load_dwordx4 v11, s[24:27], s40 offen lds
    s_add_u32 m0, s54, 40960
    s_add_u32 s40, s52, 82432
    buffer_load_dwordx4 v10, s[20:23], s40 offen lds
    s_add_u32 m0, s54, 57344
    s_add_u32 s40, s53, 1105920
    buffer_load_dwordx4 v11, s[24:27], s40 offen lds
    s_add_u32 m0, s54, 45056
    s_add_u32 s40, s52, 123392
    buffer_load_dwordx4 v10, s[20:23], s40 offen lds
    s_add_u32 m0, s54, 61440
    s_add_u32 s40, s53, 1167360
    buffer_load_dwordx4 v11, s[24:27], s40 offen lds
    s_waitcnt vmcnt(8) lgkmcnt(0)
    s_barrier
    v_add_u32 v14, 4294901760, v14
    v_add_u32 v15, 4294901760, v15
    v_add_u32 v16, 4294901760, v16
    v_add_u32 v17, 4294901760, v17
    ds_read_b128 v[112:115], v14 offset:0
    ds_read_b128 v[116:119], v15 offset:0
    ds_read_b128 v[120:123], v16 offset:0
    ds_read_b128 v[124:127], v17 offset:0
    s_add_u32 m0, s54, 65536
    s_add_u32 s40, s52, 640
    buffer_load_dwordx4 v10, s[20:23], s40 offen lds
    s_add_u32 m0, s54, 81920
    s_add_u32 s40, s53, 1228800
    buffer_load_dwordx4 v11, s[24:27], s40 offen lds
    s_add_u32 m0, s54, 69632
    s_add_u32 s40, s52, 41600
    buffer_load_dwordx4 v10, s[20:23], s40 offen lds
    s_add_u32 m0, s54, 86016
    s_add_u32 s40, s53, 1290240
    buffer_load_dwordx4 v11, s[24:27], s40 offen lds
    s_add_u32 m0, s54, 73728
    s_add_u32 s40, s52, 82560
    buffer_load_dwordx4 v10, s[20:23], s40 offen lds
    s_add_u32 m0, s54, 90112
    s_add_u32 s40, s53, 1351680
    buffer_load_dwordx4 v11, s[24:27], s40 offen lds
    s_add_u32 m0, s54, 77824
    s_add_u32 s40, s52, 123520
    buffer_load_dwordx4 v10, s[20:23], s40 offen lds
    s_add_u32 m0, s54, 94208
    s_add_u32 s40, s53, 1413120
    buffer_load_dwordx4 v11, s[24:27], s40 offen lds
    s_waitcnt vmcnt(8) lgkmcnt(0)
    s_barrier
    ds_read_b128 v[128:131], v14 offset:32768
    ds_read_b128 v[132:135], v15 offset:32768
    ds_read_b128 v[136:139], v16 offset:32768
    ds_read_b128 v[140:143], v17 offset:32768
    s_add_u32 m0, s54, 0
    s_add_u32 s40, s52, 768
    buffer_load_dwordx4 v10, s[20:23], s40 offen lds
    s_add_u32 m0, s54, 16384
    s_add_u32 s40, s53, 1474560
    buffer_load_dwordx4 v11, s[24:27], s40 offen lds
    s_add_u32 m0, s54, 4096
    s_add_u32 s40, s52, 41728
    buffer_load_dwordx4 v10, s[20:23], s40 offen lds
    s_add_u32 m0, s54, 20480
    s_add_u32 s40, s53, 1536000
    buffer_load_dwordx4 v11, s[24:27], s40 offen lds
    s_add_u32 m0, s54, 8192
    s_add_u32 s40, s52, 82688
    buffer_load_dwordx4 v10, s[20:23], s40 offen lds
    s_add_u32 m0, s54, 24576
    s_add_u32 s40, s53, 1597440
    buffer_load_dwordx4 v11, s[24:27], s40 offen lds
    s_add_u32 m0, s54, 12288
    s_add_u32 s40, s52, 123648
    buffer_load_dwordx4 v10, s[20:23], s40 offen lds
    s_add_u32 m0, s54, 28672
    s_add_u32 s40, s53, 1658880
    buffer_load_dwordx4 v11, s[24:27], s40 offen lds
    s_waitcnt vmcnt(8) lgkmcnt(0)
    s_barrier
    v_add_u32 v14, 65536, v14
    v_add_u32 v15, 65536, v15
    v_add_u32 v16, 65536, v16
    v_add_u32 v17, 65536, v17
    ds_read_b128 v[144:147], v14 offset:0
    ds_read_b128 v[148:151], v15 offset:0
    ds_read_b128 v[152:155], v16 offset:0
    ds_read_b128 v[156:159], v17 offset:0
    s_add_u32 m0, s54, 32768
    s_add_u32 s40, s52, 896
    buffer_load_dwordx4 v10, s[20:23], s40 offen lds
    s_add_u32 m0, s54, 49152
    s_add_u32 s40, s53, 1720320
    buffer_load_dwordx4 v11, s[24:27], s40 offen lds
    s_add_u32 m0, s54, 36864
    s_add_u32 s40, s52, 41856
    buffer_load_dwordx4 v10, s[20:23], s40 offen lds
    s_add_u32 m0, s54, 53248
    s_add_u32 s40, s53, 1781760
    buffer_load_dwordx4 v11, s[24:27], s40 offen lds
    s_add_u32 m0, s54, 40960
    s_add_u32 s40, s52, 82816
    buffer_load_dwordx4 v10, s[20:23], s40 offen lds
    s_add_u32 m0, s54, 57344
    s_add_u32 s40, s53, 1843200
    buffer_load_dwordx4 v11, s[24:27], s40 offen lds
    s_add_u32 m0, s54, 45056
    s_add_u32 s40, s52, 123776
    buffer_load_dwordx4 v10, s[20:23], s40 offen lds
    s_add_u32 m0, s54, 61440
    s_add_u32 s40, s53, 1904640
    buffer_load_dwordx4 v11, s[24:27], s40 offen lds
    s_waitcnt vmcnt(8) lgkmcnt(0)
    s_barrier
    v_add_u32 v14, 4294901760, v14
    v_add_u32 v15, 4294901760, v15
    v_add_u32 v16, 4294901760, v16
    v_add_u32 v17, 4294901760, v17
    ds_read_b128 v[160:163], v14 offset:0
    ds_read_b128 v[164:167], v15 offset:0
    ds_read_b128 v[168:171], v16 offset:0
    ds_read_b128 v[172:175], v17 offset:0
    s_add_u32 m0, s54, 65536
    s_add_u32 s40, s52, 1024
    buffer_load_dwordx4 v10, s[20:23], s40 offen lds
    s_add_u32 m0, s54, 81920
    s_add_u32 s40, s53, 1966080
    buffer_load_dwordx4 v11, s[24:27], s40 offen lds
    s_add_u32 m0, s54, 69632
    s_add_u32 s40, s52, 41984
    buffer_load_dwordx4 v10, s[20:23], s40 offen lds
    s_add_u32 m0, s54, 86016
    s_add_u32 s40, s53, 2027520
    buffer_load_dwordx4 v11, s[24:27], s40 offen lds
    s_add_u32 m0, s54, 73728
    s_add_u32 s40, s52, 82944
    buffer_load_dwordx4 v10, s[20:23], s40 offen lds
    s_add_u32 m0, s54, 90112
    s_add_u32 s40, s53, 2088960
    buffer_load_dwordx4 v11, s[24:27], s40 offen lds
    s_add_u32 m0, s54, 77824
    s_add_u32 s40, s52, 123904
    buffer_load_dwordx4 v10, s[20:23], s40 offen lds
    s_add_u32 m0, s54, 94208
    s_add_u32 s40, s53, 2150400
    buffer_load_dwordx4 v11, s[24:27], s40 offen lds
    s_waitcnt vmcnt(8) lgkmcnt(0)
    s_barrier
    ds_read_b128 v[176:179], v14 offset:32768
    ds_read_b128 v[180:183], v15 offset:32768
    ds_read_b128 v[184:187], v16 offset:32768
    ds_read_b128 v[188:191], v17 offset:32768
    s_add_u32 m0, s54, 0
    s_add_u32 s40, s52, 1152
    buffer_load_dwordx4 v10, s[20:23], s40 offen lds
    s_add_u32 m0, s54, 4096
    s_add_u32 s40, s52, 42112
    buffer_load_dwordx4 v10, s[20:23], s40 offen lds
    s_add_u32 m0, s54, 8192
    s_add_u32 s40, s52, 83072
    buffer_load_dwordx4 v10, s[20:23], s40 offen lds
    s_add_u32 m0, s54, 12288
    s_add_u32 s40, s52, 124032
    buffer_load_dwordx4 v10, s[20:23], s40 offen lds
    s_add_u32 m0, s54, 16384
    s_add_u32 s40, s53, 2211840
    buffer_load_dwordx4 v11, s[24:27], s40 offen lds
    s_add_u32 m0, s54, 20480
    s_add_u32 s40, s53, 2273280
    buffer_load_dwordx4 v11, s[24:27], s40 offen lds
    s_add_u32 m0, s54, 24576
    s_add_u32 s40, s53, 2334720
    buffer_load_dwordx4 v11, s[24:27], s40 offen lds
    s_add_u32 m0, s54, 28672
    s_add_u32 s40, s53, 2396160
    buffer_load_dwordx4 v11, s[24:27], s40 offen lds
    s_waitcnt vmcnt(8) lgkmcnt(0)
    s_barrier
    v_add_u32 v14, 65536, v14
    v_add_u32 v15, 65536, v15
    v_add_u32 v16, 65536, v16
    v_add_u32 v17, 65536, v17
    ds_read_b128 v[192:195], v14 offset:0
    ds_read_b128 v[196:199], v15 offset:0
    ds_read_b128 v[200:203], v16 offset:0
    ds_read_b128 v[204:207], v17 offset:0
    s_mul_i32 s41, s33, 5120
    s_mul_i32 s42, s33, 245760
    s_add_u32 s42, s42, s53
    s_add_u32 s42, s42, 0
    s_add_u32 m0, s41, 98304
    s_nop 0
    buffer_load_dwordx4 v12, s[24:27], s42 offen lds
    s_add_u32 m0, s41, 99328
    s_nop 0
    buffer_load_dwordx4 v13, s[24:27], s42 offen lds
    s_add_u32 m0, s41, 100352
    s_nop 0
    buffer_load_dwordx4 v22, s[24:27], s42 offen lds
    s_add_u32 m0, s41, 101376
    s_nop 0
    buffer_load_dwordx4 v23, s[24:27], s42 offen lds
    s_add_u32 m0, s41, 102400
    s_nop 0
    buffer_load_dwordx4 v62, s[24:27], s42 offen lds
WQ_9:
    s_waitcnt vmcnt(7) lgkmcnt(0)
    s_barrier
    v_add_u32 v14, 4294901760, v14
    v_add_u32 v15, 4294901760, v15
    v_add_u32 v16, 4294901760, v16
    v_add_u32 v17, 4294901760, v17
    ds_read_b128 v[208:211], v14 offset:0
    ds_read_b128 v[212:215], v15 offset:0
    ds_read_b128 v[216:219], v16 offset:0
    ds_read_b128 v[220:223], v17 offset:0
    s_waitcnt vmcnt(5)
    s_barrier
    s_mul_i32 s41, s33, 5120
    s_mul_i32 s42, s33, 245760
    s_add_u32 s42, s42, s53
    s_add_u32 s42, s42, 983040
    s_add_u32 m0, s41, 118784
    s_nop 0
    buffer_load_dwordx4 v12, s[24:27], s42 offen lds
    s_add_u32 m0, s41, 119808
    s_nop 0
    buffer_load_dwordx4 v13, s[24:27], s42 offen lds
    s_add_u32 m0, s41, 120832
    s_nop 0
    buffer_load_dwordx4 v22, s[24:27], s42 offen lds
    s_add_u32 m0, s41, 121856
    s_nop 0
    buffer_load_dwordx4 v23, s[24:27], s42 offen lds
    s_add_u32 m0, s41, 122880
    s_nop 0
    buffer_load_dwordx4 v62, s[24:27], s42 offen lds
WQ_10:
    s_cmp_ge_u32 s33, 2
    s_cbranch_scc1 WQ_11
    s_mul_i32 s41, s33, 5120
    s_mul_i32 s42, s33, 245760
    s_add_u32 s42, s42, s53
    s_add_u32 s42, s42, 1966080
    s_add_u32 m0, s41, 139264
    s_nop 0
    buffer_load_dwordx4 v12, s[24:27], s42 offen lds
    s_add_u32 m0, s41, 140288
    s_nop 0
    buffer_load_dwordx4 v13, s[24:27], s42 offen lds
    s_add_u32 m0, s41, 141312
    s_nop 0
    buffer_load_dwordx4 v22, s[24:27], s42 offen lds
    s_add_u32 m0, s41, 142336
    s_nop 0
    buffer_load_dwordx4 v23, s[24:27], s42 offen lds
    s_add_u32 m0, s41, 143360
    s_nop 0
    buffer_load_dwordx4 v62, s[24:27], s42 offen lds
WQ_11:
    v_lshrrev_b32 v2, 4, v0
    v_bfe_u32 v3, v0, 2, 2
    v_and_b32 v4, 3, v0
    v_and_b32 v5, 1, v2
    v_lshlrev_b32 v5, 1, v5
    v_lshrrev_b32 v6, 1, v4
    v_add_u32 v5, v5, v6
    v_and_b32 v6, 1, v4
    v_lshrrev_b32 v7, 1, v2
    v_lshlrev_b32 v7, 3, v7
    v_add_u32 v7, v7, v3
    v_mul_u32_u24 v7, 80, v7
    v_mul_u32_u24 v6, 40, v6
    v_add_u32 v7, v7, v6
    v_add_u32 v7, 98304, v7
    v_lshlrev_b32 v5, 3, v5
    v_add_u32 v18, v7, v5
    v_add_u32 v19, 32, v7
    s_waitcnt lgkmcnt(0)
    v_mov_b32 v60, 153604
    v_mov_b32 v61, 1
    s_mov_b64 exec, 1
    ds_add_u32 v60, v61
    s_mov_b64 exec, -1
    v_lshrrev_b32 v2, 4, v0
    v_bfe_u32 v3, v0, 2, 2
    v_and_b32 v4, 3, v0
    v_and_b32 v5, 1, v2
    v_lshlrev_b32 v5, 1, v5
    v_lshrrev_b32 v6, 1, v4
    v_add_u32 v5, v5, v6
    v_and_b32 v6, 1, v4
    v_mul_u32_u24 v7, 800, v6
    v_mul_u32_u24 v8, 40, v3
    v_add_u32 v7, v7, v8
    v_lshlrev_b32 v8, 3, v5
    v_add_u32 v7, v7, v8
    v_add_u32 v7, 149504, v7
    v_lshrrev_b32 v8, 1, v2
    v_mov_b32 v21, 151552
    v_cmp_eq_u32 vcc, v8, v6
    s_nop 1
    v_cndmask_b32 v20, v21, v7, vcc
    v_cmp_eq_u32 s[46:47], 0, v5
    s_nop 1
    s_and_b64 vcc, vcc, s[46:47]
    v_add_u32 v7, 32, v7
    s_nop 0
    v_cndmask_b32 v21, v21, v7, vcc
    v_lshrrev_b32 v2, 4, v0
    v_bfe_u32 v3, v0, 2, 2
    v_and_b32 v4, 3, v0
    v_and_b32 v5, 1, v2
    v_lshlrev_b32 v5, 1, v5
    v_lshrrev_b32 v6, 1, v4
    v_add_u32 v5, v5, v6
    v_and_b32 v6, 1, v4
    v_mul_u32_u24 v7, 1920, v6
    v_mul_u32_u24 v8, 48, v3
    v_lshlrev_b32 v9, 3, v5
    v_add3_u32 v7, v7, v8, v9
    v_add_u32 v7, 154624, v7
    v_lshrrev_b32 v8, 1, v2
    v_mov_b32 v9, 151552
    v_cmp_eq_u32 vcc, v8, v6
    s_nop 1
    v_cndmask_b32 v56, v9, v7, vcc
    v_cmp_gt_u32 s[46:47], 2, v5
    s_nop 1
    s_and_b64 vcc, vcc, s[46:47]
    v_add_u32 v7, 32, v7
    s_nop 0
    v_cndmask_b32 v57, v9, v7, vcc
    v_and_b32 v2, 15, v0
    v_lshlrev_b32 v2, 4, v2
    v_bfe_u32 v3, v0, 4, 1
    v_mul_u32_u24 v3, 20480, v3
    v_add_u32 v2, v2, v3
    v_lshrrev_b32 v4, 5, v0
    v_lshlrev_b32 v5, 11, v4
    v_add_u32 v58, v5, v2
    v_lshlrev_b32 v6, 3, v4
    v_add_u32 v59, v6, v2
    s_lshl_b32 s44, s34, 3
    s_lshl_b32 s41, s33, 1
    s_add_u32 s44, s44, s41
    s_mul_i32 s44, s44, 20480
    s_mul_i32 s41, s66, 5120
    s_add_u32 s44, s44, s41
    s_lshl_b32 s41, s67, 8
    s_add_u32 s44, s44, s41
    s_add_u32 s44, s44, 1048576
    s_add_u32 s45, s44, 4096
    s_waitcnt vmcnt(0)
    v_mov_b32 v60, 153628
    v_mov_b32 v61, 1
    s_mov_b64 exec, 1
    ds_add_u32 v60, v61
    s_mov_b64 exec, -1
    v_mov_b32 v60, 153628
    s_mov_b32 s60, 524288
SW_12:
    s_sub_u32 s60, s60, 1
    s_cbranch_scc1 L_end
    ds_read_b32 v61, v60
    s_waitcnt lgkmcnt(0)
    v_readfirstlane_b32 s40, v61
    s_nop 0
    s_cmp_lt_u32 s40, 4
    s_cbranch_scc1 SW_12
    v_mov_b32 v60, 153600
    s_mov_b32 s60, 524288
SW_13:
    s_sub_u32 s60, s60, 1
    s_cbranch_scc1 L_end
    ds_read_b32 v61, v60
    s_waitcnt lgkmcnt(0)
    v_readfirstlane_b32 s40, v61
    s_nop 0
    s_cmp_lt_u32 s40, 4
    s_cbranch_scc1 SW_13
    ds_read_b64_tr_b16 v[24:25], v18 offset:0
    ds_read_b64_tr_b16 v[26:27], v18 offset:320
    ds_read_b64_tr_b16 v[28:29], v19 offset:0
    ds_read_b64_tr_b16 v[30:31], v19 offset:320
    ds_read_b64_tr_b16 v[32:33], v18 offset:1280
    ds_read_b64_tr_b16 v[34:35], v18 offset:1600
    ds_read_b64_tr_b16 v[36:37], v19 offset:1280
    ds_read_b64_tr_b16 v[38:39], v19 offset:1600
    ds_read_b64_tr_b16 v[40:41], v18 offset:2560
    ds_read_b64_tr_b16 v[42:43], v18 offset:2880
    ds_read_b64_tr_b16 v[44:45], v19 offset:2560
    ds_read_b64_tr_b16 v[46:47], v19 offset:2880
    s_waitcnt lgkmcnt(8)
    v_mfma_f32_32x32x16_bf16 v[224:239], v[24:27], v[64:67], 0
    ds_read_b64_tr_b16 v[48:49], v18 offset:3840
    ds_read_b64_tr_b16 v[50:51], v18 offset:4160
    v_mfma_f32_32x32x16_bf16 v[240:255], v[28:31], v[64:67], 0
    ds_read_b64_tr_b16 v[52:53], v19 offset:3840
    ds_read_b64_tr_b16 v[54:55], v19 offset:4160
    s_waitcnt lgkmcnt(8)
    v_mfma_f32_32x32x16_bf16 v[224:239], v[32:35], v[68:71], v[224:239]
    ds_read_b64_tr_b16 v[24:25], v18 offset:5120
    ds_read_b64_tr_b16 v[26:27], v18 offset:5440
    v_mfma_f32_32x32x16_bf16 v[240:255], v[36:39], v[68:71], v[240:255]
    ds_read_b64_tr_b16 v[28:29], v19 offset:5120
    ds_read_b64_tr_b16 v[30:31], v19 offset:5440
    s_waitcnt lgkmcnt(8)
    v_mfma_f32_32x32x16_bf16 v[224:239], v[40:43], v[72:75], v[224:239]
    ds_read_b64_tr_b16 v[32:33], v18 offset:6400
    ds_read_b64_tr_b16 v[34:35], v18 offset:6720
    v_mfma_f32_32x32x16_bf16 v[240:255], v[44:47], v[72:75], v[240:255]
    ds_read_b64_tr_b16 v[36:37], v19 offset:6400
    ds_read_b64_tr_b16 v[38:39], v19 offset:6720
    s_waitcnt lgkmcnt(8)
    v_mfma_f32_32x32x16_bf16 v[224:239], v[48:51], v[76:79], v[224:239]
    ds_read_b64_tr_b16 v[40:41], v18 offset:7680
    ds_read_b64_tr_b16 v[42:43], v18 offset:8000
    v_mfma_f32_32x32x16_bf16 v[240:255], v[52:55], v[76:79], v[240:255]
    ds_read_b64_tr_b16 v[44:45], v19 offset:7680
    ds_read_b64_tr_b16 v[46:47], v19 offset:8000
    s_waitcnt lgkmcnt(8)
    v_mfma_f32_32x32x16_bf16 v[224:239], v[24:27], v[80:83], v[224:239]
    ds_read_b64_tr_b16 v[48:49], v18 offset:8960
    ds_read_b64_tr_b16 v[50:51], v18 offset:9280
    v_mfma_f32_32x32x16_bf16 v[240:255], v[28:31], v[80:83], v[240:255]
    ds_read_b64_tr_b16 v[52:53], v19 offset:8960
    ds_read_b64_tr_b16 v[54:55], v19 offset:9280
    s_waitcnt lgkmcnt(8)
    v_mfma_f32_32x32x16_bf16 v[224:239], v[32:35], v[84:87], v[224:239]
    ds_read_b64_tr_b16 v[24:25], v18 offset:10240
    ds_read_b64_tr_b16 v[26:27], v18 offset:10560
    v_mfma_f32_32x32x16_bf16 v[240:255], v[36:39], v[84:87], v[240:255]
    ds_read_b64_tr_b16 v[28:29], v19 offset:10240
    ds_read_b64_tr_b16 v[30:31], v19 offset:10560
    s_waitcnt lgkmcnt(8)
    v_mfma_f32_32x32x16_bf16 v[224:239], v[40:43], v[88:91], v[224:239]
    ds_read_b64_tr_b16 v[32:33], v18 offset:11520
    ds_read_b64_tr_b16 v[34:35], v18 offset:11840
    v_mfma_f32_32x32x16_bf16 v[240:255], v[44:47], v[88:91], v[240:255]
    ds_read_b64_tr_b16 v[36:37], v19 offset:11520
    ds_read_b64_tr_b16 v[38:39], v19 offset:11840
    s_waitcnt lgkmcnt(8)
    v_mfma_f32_32x32x16_bf16 v[224:239], v[48:51], v[92:95], v[224:239]
    ds_read_b64_tr_b16 v[40:41], v18 offset:12800
    ds_read_b64_tr_b16 v[42:43], v18 offset:13120
    v_mfma_f32_32x32x16_bf16 v[240:255], v[52:55], v[92:95], v[240:255]
    ds_read_b64_tr_b16 v[44:45], v19 offset:12800
    ds_read_b64_tr_b16 v[46:47], v19 offset:13120
    s_waitcnt lgkmcnt(8)
    v_mfma_f32_32x32x16_bf16 v[224:239], v[24:27], v[96:99], v[224:239]
    ds_read_b64_tr_b16 v[48:49], v18 offset:14080
    ds_read_b64_tr_b16 v[50:51], v18 offset:14400
    v_mfma_f32_32x32x16_bf16 v[240:255], v[28:31], v[96:99], v[240:255]
    ds_read_b64_tr_b16 v[52:53], v19 offset:14080
    ds_read_b64_tr_b16 v[54:55], v19 offset:14400
    s_waitcnt lgkmcnt(8)
    v_mfma_f32_32x32x16_bf16 v[224:239], v[32:35], v[100:103], v[224:239]
    ds_read_b64_tr_b16 v[24:25], v18 offset:15360
    ds_read_b64_tr_b16 v[26:27], v18 offset:15680
    v_mfma_f32_32x32x16_bf16 v[240:255], v[36:39], v[100:103], v[240:255]
    ds_read_b64_tr_b16 v[28:29], v19 offset:15360
    ds_read_b64_tr_b16 v[30:31], v19 offset:15680
    s_waitcnt lgkmcnt(8)
    v_mfma_f32_32x32x16_bf16 v[224:239], v[40:43], v[104:107], v[224:239]
    ds_read_b64_tr_b16 v[32:33], v18 offset:16640
    ds_read_b64_tr_b16 v[34:35], v18 offset:16960
    v_mfma_f32_32x32x16_bf16 v[240:255], v[44:47], v[104:107], v[240:255]
    ds_read_b64_tr_b16 v[36:37], v19 offset:16640
    ds_read_b64_tr_b16 v[38:39], v19 offset:16960
    s_waitcnt lgkmcnt(8)
    v_mfma_f32_32x32x16_bf16 v[224:239], v[48:51], v[108:111], v[224:239]
    ds_read_b64_tr_b16 v[40:41], v18 offset:17920
    ds_read_b64_tr_b16 v[42:43], v18 offset:18240
    v_mfma_f32_32x32x16_bf16 v[240:255], v[52:55], v[108:111], v[240:255]
    ds_read_b64_tr_b16 v[44:45], v19 offset:17920
    ds_read_b64_tr_b16 v[46:47], v19 offset:18240
    s_waitcnt lgkmcnt(8)
    v_mfma_f32_32x32x16_bf16 v[224:239], v[24:27], v[112:115], v[224:239]
    ds_read_b64_tr_b16 v[48:49], v18 offset:19200
    ds_read_b64_tr_b16 v[50:51], v18 offset:19520
    v_mfma_f32_32x32x16_bf16 v[240:255], v[28:31], v[112:115], v[240:255]
    ds_read_b64_tr_b16 v[52:53], v19 offset:19200
    ds_read_b64_tr_b16 v[54:55], v19 offset:19520
    s_waitcnt lgkmcnt(8)
    v_mfma_f32_32x32x16_bf16 v[224:239], v[32:35], v[116:119], v[224:239]
    ds_read_b64_tr_b16 v[24:25], v18 offset:20480
    ds_read_b64_tr_b16 v[26:27], v18 offset:20800
    v_mfma_f32_32x32x16_bf16 v[240:255], v[36:39], v[116:119], v[240:255]
    ds_read_b64_tr_b16 v[28:29], v19 offset:20480
    ds_read_b64_tr_b16 v[30:31], v19 offset:20800
    s_waitcnt lgkmcnt(8)
    v_mfma_f32_32x32x16_bf16 v[224:239], v[40:43], v[120:123], v[224:239]
    ds_read_b64_tr_b16 v[32:33], v18 offset:21760
    ds_read_b64_tr_b16 v[34:35], v18 offset:22080
    v_mfma_f32_32x32x16_bf16 v[240:255], v[44:47], v[120:123], v[240:255]
    ds_read_b64_tr_b16 v[36:37], v19 offset:21760
    ds_read_b64_tr_b16 v[38:39], v19 offset:22080
    s_waitcnt lgkmcnt(8)
    v_mfma_f32_32x32x16_bf16 v[224:239], v[48:51], v[124:127], v[224:239]
    ds_read_b64_tr_b16 v[40:41], v18 offset:23040
    ds_read_b64_tr_b16 v[42:43], v18 offset:23360
    v_mfma_f32_32x32x16_bf16 v[240:255], v[52:55], v[124:127], v[240:255]
    ds_read_b64_tr_b16 v[44:45], v19 offset:23040
    ds_read_b64_tr_b16 v[46:47], v19 offset:23360
    s_waitcnt lgkmcnt(8)
    v_mfma_f32_32x32x16_bf16 v[224:239], v[24:27], v[128:131], v[224:239]
    ds_read_b64_tr_b16 v[48:49], v18 offset:24320
    ds_read_b64_tr_b16 v[50:51], v18 offset:24640
    v_mfma_f32_32x32x16_bf16 v[240:255], v[28:31], v[128:131], v[240:255]
    ds_read_b64_tr_b16 v[52:53], v19 offset:24320
    ds_read_b64_tr_b16 v[54:55], v19 offset:24640
    s_waitcnt lgkmcnt(8)
    v_mfma_f32_32x32x16_bf16 v[224:239], v[32:35], v[132:135], v[224:239]
    ds_read_b64_tr_b16 v[24:25], v18 offset:25600
    ds_read_b64_tr_b16 v[26:27], v18 offset:25920
    v_mfma_f32_32x32x16_bf16 v[240:255], v[36:39], v[132:135], v[240:255]
    ds_read_b64_tr_b16 v[28:29], v19 offset:25600
    ds_read_b64_tr_b16 v[30:31], v19 offset:25920
    s_waitcnt lgkmcnt(8)
    v_mfma_f32_32x32x16_bf16 v[224:239], v[40:43], v[136:139], v[224:239]
    ds_read_b64_tr_b16 v[32:33], v18 offset:26880
    ds_read_b64_tr_b16 v[34:35], v18 offset:27200
    v_mfma_f32_32x32x16_bf16 v[240:255], v[44:47], v[136:139], v[240:255]
    ds_read_b64_tr_b16 v[36:37], v19 offset:26880
    ds_read_b64_tr_b16 v[38:39], v19 offset:27200
    s_waitcnt lgkmcnt(8)
    v_mfma_f32_32x32x16_bf16 v[224:239], v[48:51], v[140:143], v[224:239]
    ds_read_b64_tr_b16 v[40:41], v18 offset:28160
    ds_read_b64_tr_b16 v[42:43], v18 offset:28480
    v_mfma_f32_32x32x16_bf16 v[240:255], v[52:55], v[140:143], v[240:255]
    ds_read_b64_tr_b16 v[44:45], v19 offset:28160
    ds_read_b64_tr_b16 v[46:47], v19 offset:28480
    s_waitcnt lgkmcnt(8)
    v_mfma_f32_32x32x16_bf16 v[224:239], v[24:27], v[144:147], v[224:239]
    ds_read_b64_tr_b16 v[48:49], v18 offset:29440
    ds_read_b64_tr_b16 v[50:51], v18 offset:29760
    v_mfma_f32_32x32x16_bf16 v[240:255], v[28:31], v[144:147], v[240:255]
    ds_read_b64_tr_b16 v[52:53], v19 offset:29440
    ds_read_b64_tr_b16 v[54:55], v19 offset:29760
    s_waitcnt lgkmcnt(8)
    v_mfma_f32_32x32x16_bf16 v[224:239], v[32:35], v[148:151], v[224:239]
    ds_read_b64_tr_b16 v[24:25], v18 offset:30720
    ds_read_b64_tr_b16 v[26:27], v18 offset:31040
    v_mfma_f32_32x32x16_bf16 v[240:255], v[36:39], v[148:151], v[240:255]
    ds_read_b64_tr_b16 v[28:29], v19 offset:30720
    ds_read_b64_tr_b16 v[30:31], v19 offset:31040
    s_waitcnt lgkmcnt(8)
    v_mfma_f32_32x32x16_bf16 v[224:239], v[40:43], v[152:155], v[224:239]
    ds_read_b64_tr_b16 v[32:33], v18 offset:32000
    ds_read_b64_tr_b16 v[34:35], v18 offset:32320
    v_mfma_f32_32x32x16_bf16 v[240:255], v[44:47], v[152:155], v[240:255]
    ds_read_b64_tr_b16 v[36:37], v19 offset:32000
    ds_read_b64_tr_b16 v[38:39], v19 offset:32320
    s_waitcnt lgkmcnt(8)
    v_mfma_f32_32x32x16_bf16 v[224:239], v[48:51], v[156:159], v[224:239]
    ds_read_b64_tr_b16 v[40:41], v18 offset:33280
    ds_read_b64_tr_b16 v[42:43], v18 offset:33600
    v_mfma_f32_32x32x16_bf16 v[240:255], v[52:55], v[156:159], v[240:255]
    ds_read_b64_tr_b16 v[44:45], v19 offset:33280
    ds_read_b64_tr_b16 v[46:47], v19 offset:33600
    s_waitcnt lgkmcnt(8)
    v_mfma_f32_32x32x16_bf16 v[224:239], v[24:27], v[160:163], v[224:239]
    ds_read_b64_tr_b16 v[48:49], v18 offset:34560
    ds_read_b64_tr_b16 v[50:51], v18 offset:34880
    v_mfma_f32_32x32x16_bf16 v[240:255], v[28:31], v[160:163], v[240:255]
    ds_read_b64_tr_b16 v[52:53], v19 offset:34560
    ds_read_b64_tr_b16 v[54:55], v19 offset:34880
    s_waitcnt lgkmcnt(8)
    v_mfma_f32_32x32x16_bf16 v[224:239], v[32:35], v[164:167], v[224:239]
    ds_read_b64_tr_b16 v[24:25], v18 offset:35840
    ds_read_b64_tr_b16 v[26:27], v18 offset:36160
    v_mfma_f32_32x32x16_bf16 v[240:255], v[36:39], v[164:167], v[240:255]
    ds_read_b64_tr_b16 v[28:29], v19 offset:35840
    ds_read_b64_tr_b16 v[30:31], v19 offset:36160
    s_waitcnt lgkmcnt(8)
    v_mfma_f32_32x32x16_bf16 v[224:239], v[40:43], v[168:171], v[224:239]
    ds_read_b64_tr_b16 v[32:33], v18 offset:37120
    ds_read_b64_tr_b16 v[34:35], v18 offset:37440
    v_mfma_f32_32x32x16_bf16 v[240:255], v[44:47], v[168:171], v[240:255]
    ds_read_b64_tr_b16 v[36:37], v19 offset:37120
    ds_read_b64_tr_b16 v[38:39], v19 offset:37440
    s_waitcnt lgkmcnt(8)
    v_mfma_f32_32x32x16_bf16 v[224:239], v[48:51], v[172:175], v[224:239]
    ds_read_b64_tr_b16 v[40:41], v18 offset:38400
    ds_read_b64_tr_b16 v[42:43], v18 offset:38720
    v_mfma_f32_32x32x16_bf16 v[240:255], v[52:55], v[172:175], v[240:255]
    ds_read_b64_tr_b16 v[44:45], v19 offset:38400
    ds_read_b64_tr_b16 v[46:47], v19 offset:38720
    s_waitcnt lgkmcnt(8)
    v_mfma_f32_32x32x16_bf16 v[224:239], v[24:27], v[176:179], v[224:239]
    ds_read_b64_tr_b16 v[48:49], v18 offset:39680
    ds_read_b64_tr_b16 v[50:51], v18 offset:40000
    v_mfma_f32_32x32x16_bf16 v[240:255], v[28:31], v[176:179], v[240:255]
    ds_read_b64_tr_b16 v[52:53], v19 offset:39680
    ds_read_b64_tr_b16 v[54:55], v19 offset:40000
    s_waitcnt lgkmcnt(8)
    v_mfma_f32_32x32x16_bf16 v[224:239], v[32:35], v[180:183], v[224:239]
    ds_read_b64_tr_b16 v[24:25], v18 offset:40960
    ds_read_b64_tr_b16 v[26:27], v18 offset:41280
    v_mfma_f32_32x32x16_bf16 v[240:255], v[36:39], v[180:183], v[240:255]
    ds_read_b64_tr_b16 v[28:29], v19 offset:40960
    ds_read_b64_tr_b16 v[30:31], v19 offset:41280
    s_waitcnt lgkmcnt(8)
    v_mfma_f32_32x32x16_bf16 v[224:239], v[40:43], v[184:187], v[224:239]
    ds_read_b64_tr_b16 v[32:33], v18 offset:42240
    ds_read_b64_tr_b16 v[34:35], v18 offset:42560
    v_mfma_f32_32x32x16_bf16 v[240:255], v[44:47], v[184:187], v[240:255]
    ds_read_b64_tr_b16 v[36:37], v19 offset:42240
    ds_read_b64_tr_b16 v[38:39], v19 offset:42560
    s_waitcnt lgkmcnt(8)
    v_mfma_f32_32x32x16_bf16 v[224:239], v[48:51], v[188:191], v[224:239]
    ds_read_b64_tr_b16 v[40:41], v18 offset:43520
    ds_read_b64_tr_b16 v[42:43], v18 offset:43840
    v_mfma_f32_32x32x16_bf16 v[240:255], v[52:55], v[188:191], v[240:255]
    ds_read_b64_tr_b16 v[44:45], v19 offset:43520
    ds_read_b64_tr_b16 v[46:47], v19 offset:43840
    s_waitcnt lgkmcnt(8)
    v_mfma_f32_32x32x16_bf16 v[224:239], v[24:27], v[192:195], v[224:239]
    ds_read_b64_tr_b16 v[48:49], v18 offset:44800
    ds_read_b64_tr_b16 v[50:51], v18 offset:45120
    v_mfma_f32_32x32x16_bf16 v[240:255], v[28:31], v[192:195], v[240:255]
    ds_read_b64_tr_b16 v[52:53], v19 offset:44800
    ds_read_b64_tr_b16 v[54:55], v19 offset:45120
    s_waitcnt lgkmcnt(8)
    v_mfma_f32_32x32x16_bf16 v[224:239], v[32:35], v[196:199], v[224:239]
    ds_read_b64_tr_b16 v[24:25], v18 offset:46080
    ds_read_b64_tr_b16 v[26:27], v18 offset:46400
    v_mfma_f32_32x32x16_bf16 v[240:255], v[36:39], v[196:199], v[240:255]
    ds_read_b64_tr_b16 v[28:29], v19 offset:46080
    ds_read_b64_tr_b16 v[30:31], v19 offset:46400
    s_waitcnt lgkmcnt(8)
    v_mfma_f32_32x32x16_bf16 v[224:239], v[40:43], v[200:203], v[224:239]
    ds_read_b64_tr_b16 v[32:33], v18 offset:47360
    ds_read_b64_tr_b16 v[34:35], v18 offset:47680
    v_mfma_f32_32x32x16_bf16 v[240:255], v[44:47], v[200:203], v[240:255]
    ds_read_b64_tr_b16 v[36:37], v19 offset:47360
    ds_read_b64_tr_b16 v[38:39], v19 offset:47680
    s_waitcnt lgkmcnt(8)
    v_mfma_f32_32x32x16_bf16 v[224:239], v[48:51], v[204:207], v[224:239]
    ds_read_b64_tr_b16 v[40:41], v18 offset:48640
    ds_read_b64_tr_b16 v[42:43], v18 offset:48960
    v_mfma_f32_32x32x16_bf16 v[240:255], v[52:55], v[204:207], v[240:255]
    ds_read_b64_tr_b16 v[44:45], v19 offset:48640
    ds_read_b64_tr_b16 v[46:47], v19 offset:48960
    s_waitcnt lgkmcnt(8)
    v_mfma_f32_32x32x16_bf16 v[224:239], v[24:27], v[208:211], v[224:239]
    ds_read_b64_tr_b16 v[48:49], v18 offset:49920
    ds_read_b64_tr_b16 v[50:51], v18 offset:50240
    v_mfma_f32_32x32x16_bf16 v[240:255], v[28:31], v[208:211], v[240:255]
    ds_read_b64_tr_b16 v[52:53], v19 offset:49920
    ds_read_b64_tr_b16 v[54:55], v19 offset:50240
    s_waitcnt lgkmcnt(8)
    v_mfma_f32_32x32x16_bf16 v[224:239], v[32:35], v[212:215], v[224:239]
    v_mfma_f32_32x32x16_bf16 v[240:255], v[36:39], v[212:215], v[240:255]
    s_waitcnt lgkmcnt(4)
    v_mfma_f32_32x32x16_bf16 v[224:239], v[40:43], v[216:219], v[224:239]
    v_mfma_f32_32x32x16_bf16 v[240:255], v[44:47], v[216:219], v[240:255]
    s_waitcnt lgkmcnt(0)
    v_mfma_f32_32x32x16_bf16 v[224:239], v[48:51], v[220:223], v[224:239]
    v_mfma_f32_32x32x16_bf16 v[240:255], v[52:55], v[220:223], v[240:255]
    ds_read_b64_tr_b16 v[64:65], v20 offset:0
    ds_read_b64_tr_b16 v[66:67], v20 offset:160
    ds_read_b64_tr_b16 v[68:69], v20 offset:320
    ds_read_b64_tr_b16 v[70:71], v20 offset:480
    ds_read_b64_tr_b16 v[72:73], v20 offset:640
    v_mov_b32 v74, 0
    v_mov_b32 v75, 0
    ds_read_b64_tr_b16 v[76:77], v21 offset:0
    ds_read_b64_tr_b16 v[78:79], v21 offset:160
    ds_read_b64_tr_b16 v[80:81], v21 offset:320
    ds_read_b64_tr_b16 v[82:83], v21 offset:480
    ds_read_b64_tr_b16 v[84:85], v21 offset:640
    v_mov_b32 v86, 0
    v_mov_b32 v87, 0
    s_nop 7
    v_cvt_pk_bf16_f32 v88, v224, v225
    v_cvt_pk_bf16_f32 v89, v226, v227
    v_cvt_pk_bf16_f32 v90, v228, v229
    v_cvt_pk_bf16_f32 v91, v230, v231
    v_cvt_pk_bf16_f32 v92, v232, v233
    v_cvt_pk_bf16_f32 v93, v234, v235
    v_cvt_pk_bf16_f32 v94, v236, v237
    v_cvt_pk_bf16_f32 v95, v238, v239
    v_cvt_pk_bf16_f32 v96, v240, v241
    v_cvt_pk_bf16_f32 v97, v242, v243
    v_mov_b32 v98, 0
    v_mov_b32 v99, 0
    s_waitcnt lgkmcnt(0)
    v_mfma_f32_32x32x16_bf16 v[100:115], v[64:67], v[88:91], 0
    v_mfma_f32_32x32x16_bf16 v[116:131], v[76:79], v[88:91], 0
    v_mfma_f32_32x32x16_bf16 v[100:115], v[68:71], v[92:95], v[100:115]
    v_mfma_f32_32x32x16_bf16 v[116:131], v[80:83], v[92:95], v[116:131]
    v_mfma_f32_32x32x16_bf16 v[100:115], v[72:75], v[96:99], v[100:115]
    v_mfma_f32_32x32x16_bf16 v[116:131], v[84:87], v[96:99], v[116:131]
    s_nop 7
    s_nop 3
    v_max3_f32 v192, v100, v101, v102
    v_min3_f32 v193, v100, v101, v102
    v_max3_f32 v192, v192, v103, v104
    v_min3_f32 v193, v193, v103, v104
    v_max3_f32 v192, v192, v105, v106
    v_min3_f32 v193, v193, v105, v106
    v_max3_f32 v192, v192, v107, v108
    v_min3_f32 v193, v193, v107, v108
    v_max3_f32 v192, v192, v109, v110
    v_min3_f32 v193, v193, v109, v110
    v_max3_f32 v192, v192, v111, v112
    v_min3_f32 v193, v193, v111, v112
    v_max3_f32 v192, v192, v113, v114
    v_min3_f32 v193, v193, v113, v114
    v_max3_f32 v192, v192, v115, v116
    v_min3_f32 v193, v193, v115, v116
    v_max3_f32 v192, v192, v117, v118
    v_min3_f32 v193, v193, v117, v118
    v_max_f32 v192, v192, v119
    v_min_f32 v193, v193, v119
    v_mul_f32 v194, 0xbfb8aa3b, v192
    v_mul_f32 v196, 0x3fb8aa3b, v193
    v_pk_fma_f32 v[132:133], v[100:101], s[56:57], v[194:195] op_sel_hi:[1,1,0]
    v_pk_fma_f32 v[152:153], v[100:101], s[56:57], v[196:197] op_sel_hi:[1,1,0] neg_lo:[1,0,0] neg_hi:[1,0,0]
    v_pk_fma_f32 v[134:135], v[102:103], s[56:57], v[194:195] op_sel_hi:[1,1,0]
    v_pk_fma_f32 v[154:155], v[102:103], s[56:57], v[196:197] op_sel_hi:[1,1,0] neg_lo:[1,0,0] neg_hi:[1,0,0]
    v_pk_fma_f32 v[136:137], v[104:105], s[56:57], v[194:195] op_sel_hi:[1,1,0]
    v_pk_fma_f32 v[156:157], v[104:105], s[56:57], v[196:197] op_sel_hi:[1,1,0] neg_lo:[1,0,0] neg_hi:[1,0,0]
    v_pk_fma_f32 v[138:139], v[106:107], s[56:57], v[194:195] op_sel_hi:[1,1,0]
    v_pk_fma_f32 v[158:159], v[106:107], s[56:57], v[196:197] op_sel_hi:[1,1,0] neg_lo:[1,0,0] neg_hi:[1,0,0]
    v_pk_fma_f32 v[140:141], v[108:109], s[56:57], v[194:195] op_sel_hi:[1,1,0]
    v_pk_fma_f32 v[160:161], v[108:109], s[56:57], v[196:197] op_sel_hi:[1,1,0] neg_lo:[1,0,0] neg_hi:[1,0,0]
    v_pk_fma_f32 v[142:143], v[110:111], s[56:57], v[194:195] op_sel_hi:[1,1,0]
    v_pk_fma_f32 v[162:163], v[110:111], s[56:57], v[196:197] op_sel_hi:[1,1,0] neg_lo:[1,0,0] neg_hi:[1,0,0]
    v_pk_fma_f32 v[144:145], v[112:113], s[56:57], v[194:195] op_sel_hi:[1,1,0]
    v_pk_fma_f32 v[164:165], v[112:113], s[56:57], v[196:197] op_sel_hi:[1,1,0] neg_lo:[1,0,0] neg_hi:[1,0,0]
    v_pk_fma_f32 v[146:147], v[114:115], s[56:57], v[194:195] op_sel_hi:[1,1,0]
    v_pk_fma_f32 v[166:167], v[114:115], s[56:57], v[196:197] op_sel_hi:[1,1,0] neg_lo:[1,0,0] neg_hi:[1,0,0]
    v_pk_fma_f32 v[148:149], v[116:117], s[56:57], v[194:195] op_sel_hi:[1,1,0]
    v_pk_fma_f32 v[168:169], v[116:117], s[56:57], v[196:197] op_sel_hi:[1,1,0] neg_lo:[1,0,0] neg_hi:[1,0,0]
    v_pk_fma_f32 v[150:151], v[118:119], s[56:57], v[194:195] op_sel_hi:[1,1,0]
    v_pk_fma_f32 v[170:171], v[118:119], s[56:57], v[196:197] op_sel_hi:[1,1,0] neg_lo:[1,0,0] neg_hi:[1,0,0]
    v_exp_f32 v132, v132
    v_exp_f32 v152, v152
    v_exp_f32 v133, v133
    v_exp_f32 v153, v153
    v_exp_f32 v134, v134
    v_exp_f32 v154, v154
    v_exp_f32 v135, v135
    v_exp_f32 v155, v155
    v_exp_f32 v136, v136
    v_exp_f32 v156, v156
    v_exp_f32 v137, v137
    v_exp_f32 v157, v157
    v_exp_f32 v138, v138
    v_exp_f32 v158, v158
    v_exp_f32 v139, v139
    v_exp_f32 v159, v159
    v_exp_f32 v140, v140
    v_exp_f32 v160, v160
    v_exp_f32 v141, v141
    v_exp_f32 v161, v161
    v_exp_f32 v142, v142
    v_exp_f32 v162, v162
    v_exp_f32 v143, v143
    v_exp_f32 v163, v163
    v_exp_f32 v144, v144
    v_exp_f32 v164, v164
    v_exp_f32 v145, v145
    v_exp_f32 v165, v165
    v_exp_f32 v146, v146
    v_exp_f32 v166, v166
    v_exp_f32 v147, v147
    v_exp_f32 v167, v167
    v_exp_f32 v148, v148
    v_exp_f32 v168, v168
    v_exp_f32 v149, v149
    v_exp_f32 v169, v169
    v_exp_f32 v150, v150
    v_exp_f32 v170, v170
    v_exp_f32 v151, v151
    v_exp_f32 v171, v171
    v_pk_add_f32 v[194:195], v[132:133], v[134:135]
    v_pk_add_f32 v[196:197], v[152:153], v[154:155]
    v_pk_add_f32 v[194:195], v[194:195], v[136:137]
    v_pk_add_f32 v[196:197], v[196:197], v[156:157]
    v_pk_add_f32 v[194:195], v[194:195], v[138:139]
    v_pk_add_f32 v[196:197], v[196:197], v[158:159]
    v_pk_add_f32 v[194:195], v[194:195], v[140:141]
    v_pk_add_f32 v[196:197], v[196:197], v[160:161]
    v_pk_add_f32 v[194:195], v[194:195], v[142:143]
    v_pk_add_f32 v[196:197], v[196:197], v[162:163]
    v_pk_add_f32 v[194:195], v[194:195], v[144:145]
    v_pk_add_f32 v[196:197], v[196:197], v[164:165]
    v_pk_add_f32 v[194:195], v[194:195], v[146:147]
    v_pk_add_f32 v[196:197], v[196:197], v[166:167]
    v_pk_add_f32 v[194:195], v[194:195], v[148:149]
    v_pk_add_f32 v[196:197], v[196:197], v[168:169]
    v_pk_add_f32 v[194:195], v[194:195], v[150:151]
    v_pk_add_f32 v[196:197], v[196:197], v[170:171]
    v_add_f32 v194, v194, v195
    v_add_f32 v196, v196, v197
    v_rcp_f32 v194, v194
    v_rcp_f32 v196, v196
    s_nop 0
    v_pk_mul_f32 v[132:133], v[132:133], v[194:195] op_sel_hi:[1,0]
    v_pk_mul_f32 v[152:153], v[152:153], v[196:197] op_sel_hi:[1,0]
    v_pk_mul_f32 v[134:135], v[134:135], v[194:195] op_sel_hi:[1,0]
    v_pk_mul_f32 v[154:155], v[154:155], v[196:197] op_sel_hi:[1,0]
    v_pk_mul_f32 v[136:137], v[136:137], v[194:195] op_sel_hi:[1,0]
    v_pk_mul_f32 v[156:157], v[156:157], v[196:197] op_sel_hi:[1,0]
    v_pk_mul_f32 v[138:139], v[138:139], v[194:195] op_sel_hi:[1,0]
    v_pk_mul_f32 v[158:159], v[158:159], v[196:197] op_sel_hi:[1,0]
    v_pk_mul_f32 v[140:141], v[140:141], v[194:195] op_sel_hi:[1,0]
    v_pk_mul_f32 v[160:161], v[160:161], v[196:197] op_sel_hi:[1,0]
    v_pk_mul_f32 v[142:143], v[142:143], v[194:195] op_sel_hi:[1,0]
    v_pk_mul_f32 v[162:163], v[162:163], v[196:197] op_sel_hi:[1,0]
    v_pk_mul_f32 v[144:145], v[144:145], v[194:195] op_sel_hi:[1,0]
    v_pk_mul_f32 v[164:165], v[164:165], v[196:197] op_sel_hi:[1,0]
    v_pk_mul_f32 v[146:147], v[146:147], v[194:195] op_sel_hi:[1,0]
    v_pk_mul_f32 v[166:167], v[166:167], v[196:197] op_sel_hi:[1,0]
    v_pk_mul_f32 v[148:149], v[148:149], v[194:195] op_sel_hi:[1,0]
    v_pk_mul_f32 v[168:169], v[168:169], v[196:197] op_sel_hi:[1,0]
    v_pk_mul_f32 v[150:151], v[150:151], v[194:195] op_sel_hi:[1,0]
    v_pk_mul_f32 v[170:171], v[170:171], v[196:197] op_sel_hi:[1,0]
    v_cvt_pk_bf16_f32 v172, v132, v133
    v_cvt_pk_bf16_f32 v182, v152, v153
    v_cvt_pk_bf16_f32 v173, v134, v135
    v_cvt_pk_bf16_f32 v183, v154, v155
    v_cvt_pk_bf16_f32 v174, v136, v137
    v_cvt_pk_bf16_f32 v184, v156, v157
    v_cvt_pk_bf16_f32 v175, v138, v139
    v_cvt_pk_bf16_f32 v185, v158, v159
    v_cvt_pk_bf16_f32 v176, v140, v141
    v_cvt_pk_bf16_f32 v186, v160, v161
    v_cvt_pk_bf16_f32 v177, v142, v143
    v_cvt_pk_bf16_f32 v187, v162, v163
    v_cvt_pk_bf16_f32 v178, v144, v145
    v_cvt_pk_bf16_f32 v188, v164, v165
    v_cvt_pk_bf16_f32 v179, v146, v147
    v_cvt_pk_bf16_f32 v189, v166, v167
    v_cvt_pk_bf16_f32 v180, v148, v149
    v_cvt_pk_bf16_f32 v190, v168, v169
    v_cvt_pk_bf16_f32 v181, v150, v151
    v_cvt_pk_bf16_f32 v191, v170, v171
    v_mov_b32 v2, 153608
    s_mov_b32 s60, 524288
SW_14:
    s_sub_u32 s60, s60, 1
    s_cbranch_scc1 L_end
    ds_read_b32 v3, v2
    s_waitcnt lgkmcnt(0)
    v_readfirstlane_b32 s40, v3
    s_nop 0
    s_cmp_lt_u32 s40, 4
    s_cbranch_scc1 SW_14
    ds_read_b64_tr_b16 v[64:65], v56 offset:0
    ds_read_b64_tr_b16 v[66:67], v56 offset:192
    ds_read_b64_tr_b16 v[84:85], v57 offset:0
    ds_read_b64_tr_b16 v[86:87], v57 offset:192
    ds_read_b64_tr_b16 v[68:69], v56 offset:384
    ds_read_b64_tr_b16 v[70:71], v56 offset:576
    ds_read_b64_tr_b16 v[88:89], v57 offset:384
    ds_read_b64_tr_b16 v[90:91], v57 offset:576
    ds_read_b64_tr_b16 v[72:73], v56 offset:768
    ds_read_b64_tr_b16 v[74:75], v56 offset:960
    ds_read_b64_tr_b16 v[92:93], v57 offset:768
    ds_read_b64_tr_b16 v[94:95], v57 offset:960
    ds_read_b64_tr_b16 v[76:77], v56 offset:1152
    ds_read_b64_tr_b16 v[78:79], v56 offset:1344
    ds_read_b64_tr_b16 v[96:97], v57 offset:1152
    ds_read_b64_tr_b16 v[98:99], v57 offset:1344
    ds_read_b64_tr_b16 v[80:81], v56 offset:1536
    ds_read_b64_tr_b16 v[82:83], v56 offset:1728
    ds_read_b64_tr_b16 v[100:101], v57 offset:1536
    ds_read_b64_tr_b16 v[102:103], v57 offset:1728
    s_waitcnt lgkmcnt(15)
    v_mfma_f32_32x32x16_bf16 v[104:119], v[64:67], v[172:175], 0
    v_mfma_f32_32x32x16_bf16 v[120:135], v[84:87], v[172:175], 0
    s_waitcnt lgkmcnt(12)
    v_mfma_f32_32x32x16_bf16 v[104:119], v[68:71], v[176:179], v[104:119]
    v_mfma_f32_32x32x16_bf16 v[120:135], v[88:91], v[176:179], v[120:135]
    s_waitcnt lgkmcnt(8)
    v_mfma_f32_32x32x16_bf16 v[104:119], v[72:75], v[180:183], v[104:119]
    v_mfma_f32_32x32x16_bf16 v[120:135], v[92:95], v[180:183], v[120:135]
    s_waitcnt lgkmcnt(4)
    v_mfma_f32_32x32x16_bf16 v[104:119], v[76:79], v[184:187], v[104:119]
    v_mfma_f32_32x32x16_bf16 v[120:135], v[96:99], v[184:187], v[120:135]
    s_waitcnt lgkmcnt(0)
    v_mfma_f32_32x32x16_bf16 v[104:119], v[80:83], v[188:191], v[104:119]
    v_mfma_f32_32x32x16_bf16 v[120:135], v[100:103], v[188:191], v[120:135]
    s_nop 7
    s_nop 3
    v_add_f32 v8, 0x358637bd, v124
    v_rcp_f32 v8, v8
    s_nop 0
    v_pk_mul_f32 v[104:105], v[104:105], v[8:9] op_sel_hi:[1,0]
    v_pk_mul_f32 v[106:107], v[106:107], v[8:9] op_sel_hi:[1,0]
    v_pk_mul_f32 v[108:109], v[108:109], v[8:9] op_sel_hi:[1,0]
    v_pk_mul_f32 v[110:111], v[110:111], v[8:9] op_sel_hi:[1,0]
    v_pk_mul_f32 v[112:113], v[112:113], v[8:9] op_sel_hi:[1,0]
    v_pk_mul_f32 v[114:115], v[114:115], v[8:9] op_sel_hi:[1,0]
    v_pk_mul_f32 v[116:117], v[116:117], v[8:9] op_sel_hi:[1,0]
    v_pk_mul_f32 v[118:119], v[118:119], v[8:9] op_sel_hi:[1,0]
    v_pk_mul_f32 v[120:121], v[120:121], v[8:9] op_sel_hi:[1,0]
    v_pk_mul_f32 v[122:123], v[122:123], v[8:9] op_sel_hi:[1,0]
    v_cvt_pk_bf16_f32 v136, v104, v105
    v_cvt_pk_bf16_f32 v137, v106, v107
    v_cvt_pk_bf16_f32 v138, v108, v109
    v_cvt_pk_bf16_f32 v139, v110, v111
    v_cvt_pk_bf16_f32 v140, v112, v113
    v_cvt_pk_bf16_f32 v141, v114, v115
    v_cvt_pk_bf16_f32 v142, v116, v117
    v_cvt_pk_bf16_f32 v143, v118, v119
    v_cvt_pk_bf16_f32 v144, v120, v121
    v_cvt_pk_bf16_f32 v145, v122, v123
    v_min_u32 v136, -2, v136
    v_min_u32 v138, -2, v138
    v_min_u32 v140, -2, v140
    v_min_u32 v142, -2, v142
    v_min_u32 v144, -2, v144
    buffer_store_dwordx4 v[136:139], v58, s[28:31], s44 offen sc1
    buffer_store_dwordx4 v[140:143], v58, s[28:31], s44 offen offset:1024 sc1
    buffer_store_dwordx2 v[144:145], v59, s[28:31], s45 offen sc1
    v_mov_b32 v2, 153620
    v_mov_b32 v3, 1
    s_mov_b64 exec, 1
    ds_add_u32 v2, v3
    s_mov_b64 exec, -1
L_fin:
L_end:
    s_endpgm
L_code_end:
.section .rodata,"a"
.p2align 6
.amdhsa_kernel standalone__linear_kernel_hedgehog__prompt_kernel
  .amdhsa_next_free_vgpr 256
  .amdhsa_next_free_sgpr 102
  .amdhsa_accum_offset 256
  .amdhsa_group_segment_fixed_size 0
  .amdhsa_kernarg_size 56
  .amdhsa_user_sgpr_count 2
  .amdhsa_user_sgpr_kernarg_segment_ptr 1
  .amdhsa_system_sgpr_workgroup_id_x 1
  .amdhsa_float_denorm_mode_32 3
  .amdhsa_float_denorm_mode_16_64 3
.end_amdhsa_kernel
```
